```python
import torch

def _softmax(x, axis=-1):
    return torch.softmax(x, dim=axis)
def _gelu(x):
    return torch.nn.functional.gelu(x, approximate="tanh")
def _silu(x):
    return torch.nn.functional.silu(x)
def _sigmoid(x):
    return torch.sigmoid(x)
def _layernorm(x, axis=-1, eps=1e-5):
    m = x.mean(dim=axis, keepdim=True)
    v = x.var(dim=axis, keepdim=True, unbiased=False)
    return (x - m) / torch.sqrt(v + eps)
def _scatter_add(tgt, idx, src, axis=0):
    return tgt.clone().index_add_(axis, idx, src)
def _segment_sum(src, seg, n):
    out = torch.zeros((n,) + src.shape[1:], dtype=src.dtype)
    return out.index_add_(0, seg, src)
def _pad(x, pw):
    flat = tuple(v for pair in reversed(pw) for v in pair)
    return torch.nn.functional.pad(x, flat)

kernel_name = 'concat_heads__grouped_kv_mqa__mha_block__prompt'

def setup_inputs():

    _w = (lambda a: (lambda t: t.to(torch.bfloat16) if t.is_floating_point() else t)(torch.as_tensor(a)))
    def _A_setup():
        B, S, D, H = 1, 2048, 1024, 32
        Dh = D // H
        return {
            "x": _w((lambda *s: torch.randn(*s, dtype=torch.bfloat16) * 0.05)(B, S, D)),
            "wq": _w((lambda *s: torch.randn(*s, dtype=torch.bfloat16) * 0.8)(D, H * Dh)),
            "wk": _w((lambda *s: torch.randn(*s, dtype=torch.bfloat16) * 0.8)(D, Dh)),
            "wv": _w((lambda *s: torch.randn(*s, dtype=torch.bfloat16) * 0.1)(D, Dh)),
            "wo": _w((lambda *s: torch.randn(*s, dtype=torch.bfloat16) * 0.1)(H * Dh, D)),
        }
    _A_in = _A_setup()

    def _B_setup():
        B, S, D, H = 1, 2048, 1024, 32
        return {
            "x": _w((lambda *s: torch.randn(*s, dtype=torch.bfloat16) * 0.2)(B, S, D)),
            "wqkv": _w((lambda *s: torch.randn(*s, dtype=torch.bfloat16) * 0.2)(D, 3 * D)),
            "wo": _w((lambda *s: torch.randn(*s, dtype=torch.bfloat16) * 0.05)(D, D)),
        }
    _B_in = _B_setup()

    return {
        "A_x": _A_in["x"],
        "A_wq": _A_in["wq"],
        "A_wk": _A_in["wk"],
        "A_wv": _A_in["wv"],
        "A_wo": _A_in["wo"],
        "B_x": _B_in["x"],
        "B_wqkv": _B_in["wqkv"],
        "B_wo": _B_in["wo"],
    }

def reference(A_x, A_wq, A_wk, A_wv, A_wo, B_x, B_wqkv, B_wo):
    def _A_ref(x, wq, wk, wv, wo):
        B, S, D = x.shape
        H = 32
        Dh = D // H
        q = (lambda x, *d: x.permute(*d))((x @ wq).reshape(B, S, H, Dh), 0, 2, 1, 3)
        k = x @ wk
        v = x @ wv
        scores = torch.einsum("bhqd,bkd->bhqk", q, k) * (Dh ** -0.5)
        p = _softmax(scores, axis=-1)
        o = torch.einsum("bhqk,bkd->bhqd", p, v)
        return (lambda x, *d: x.permute(*d))(o, 0, 2, 1, 3).reshape(B, S, H * Dh) @ wo

    def _B_ref(x, wqkv, wo):
        B, S, D = x.shape
        H = 32
        Dh = D // H
        qkv = (lambda x, *d: x.permute(*d))((x @ wqkv).reshape(B, S, 3, H, Dh), 2, 0, 3, 1, 4)
        q, k, v = qkv[0], qkv[1], qkv[2]
        scores = torch.einsum("bhqd,bhkd->bhqk", q, k) * (Dh ** -0.5)
        p = _softmax(scores, axis=-1)
        o = torch.einsum("bhqk,bhkd->bhqd", p, v)
        return (lambda x, *d: x.permute(*d))(o, 0, 2, 1, 3).reshape(B, S, D) @ wo

    a = _A_ref(A_x, A_wq, A_wk, A_wv, A_wo)
    b = _B_ref(B_x, B_wqkv, B_wo)
    return torch.concatenate([a, b], axis=-1)
```

```asm
; @launch kernel=fused_kernel grid=(256,1,1) block=(512,1,1) lds=163840
.amdgcn_target "amdgcn-amd-amdhsa--gfx950"
.text
.globl fused_kernel
.p2align 8
.type fused_kernel,@function
fused_kernel:
  s_cmp_ge_u32 s2, 256
  s_cbranch_scc1 L_fused_end
  s_and_b32 s25, s2, 7
  s_lshr_b32 s30, s2, 3
  s_and_b32 s26, s30, 7
  s_lshr_b32 s27, s30, 3
  s_load_dwordx2 s[54:55], s[0:1], 80
  s_load_dwordx2 s[98:99], s[0:1], 72
  v_lshrrev_b32 v1, 6, v0
  v_and_b32 v0, 63, v0
  v_readfirstlane_b32 s24, v1
  s_cmp_lt_u32 s25, 2
  s_cbranch_scc1 L_proj_kernel_typeA
  s_load_dwordx2 s[48:49], s[0:1], 40
  s_load_dwordx2 s[50:51], s[0:1], 48
  s_load_dwordx2 s[52:53], s[0:1], 48
  s_sub_u32 s30, s25, 2
  s_and_b32 s31, s30, 1
  s_lshl_b32 s31, s31, 3
  s_add_u32 s26, s26, s31
  s_lshr_b32 s28, s30, 1
  s_mov_b32 s29, 6144
  s_lshl_b32 s32, s28, 11
  s_lshl_b32 s33, s27, 9
  s_add_u32 s32, s32, s33
  s_mov_b32 s33, 6291456
  s_mov_b32 s39, 0
  s_branch L_proj_kernel_typed
L_proj_kernel_typeA:
  s_load_dwordx2 s[48:49], s[0:1], 0
  s_load_dwordx2 s[50:51], s[0:1], 8
  s_cmp_lt_u32 s27, 2
  s_cbranch_scc1 L_proj_kernel_typeAK
  s_load_dwordx2 s[52:53], s[0:1], 24
  s_mov_b32 s28, 4
  s_branch L_proj_kernel_typeA2
L_proj_kernel_typeAK:
  s_load_dwordx2 s[52:53], s[0:1], 16
  s_mov_b32 s28, 3
L_proj_kernel_typeA2:
  s_lshl_b32 s31, s25, 3
  s_add_u32 s26, s26, s31
  s_mov_b32 s29, 2048
  s_lshl_b32 s32, s27, 9
  s_mov_b32 s33, 2097152
  s_and_b32 s39, s27, 1
  s_lshl_b32 s39, s39, 5
L_proj_kernel_typed:
  s_mov_b32 s47, s32
  s_mov_b32 s58, s33
  s_mov_b32 s3, s24
  s_cmp_lt_u32 s24, 4
  s_cbranch_scc1 L_proj_kernel_compute
L_proj_kernel_loader:
  s_sub_u32 s24, s24, 4
  v_lshrrev_b32 v1, 3, v0
  v_lshrrev_b32 v2, 4, v0
  v_and_b32 v3, 7, v0
  v_xor_b32 v2, v2, v3
  s_lshl_b32 s30, s24, 16
  v_lshlrev_b32 v2, 4, v2
  v_lshl_add_u32 v164, v1, 11, v2
  v_add_u32 v164, s30, v164
  v_xor_b32 v165, 64, v164
  s_mov_b32 s37, 0
  s_lshl_b32 s40, s24, 12
  s_mov_b32 s36, 0
  v_lshrrev_b32 v1, 5, v0
  v_and_b32 v3, 31, v0
  v_lshlrev_b32 v2, 1, v1
  v_xor_b32 v2, v2, v3
  s_lshl_b32 s30, s24, 4
  v_add_u32 v1, s30, v1
  v_mul_lo_u32 v1, v1, s29
  v_lshl_add_u32 v168, v2, 4, v1
  v_xor_b32 v169, 64, v168
  v_xor_b32 v170, 0x80, v168
  v_xor_b32 v171, 0xc0, v168
  s_mov_b32 s38, 0
  s_lshl_b32 s46, s29, 6
  s_lshl_b32 s33, s29, 1
  s_lshl_b32 s41, s24, 13
  s_add_u32 s41, s41, 16384
  s_cmp_ge_u32 s28, 3
  s_mov_b32 s31, 65537
  s_cselect_b32 s31, 65537, s31
  s_bfe_u32 s30, s26, s31
  s_lshl_b32 s31, s30, 7
  v_xor_b32 v168, s31, v168
  v_xor_b32 v169, s31, v169
  v_xor_b32 v170, s31, v170
  v_xor_b32 v171, s31, v171
  s_lshl_b32 s31, s30, 12
  s_add_u32 s41, s41, s31
  s_mul_i32 s31, s29, 8
  s_mul_i32 s38, s31, s30
  s_mul_i32 s31, s29, -14
  s_cmp_eq_u32 s30, 0
  s_cselect_b32 s66, s33, s31
  s_mov_b32 s31, -7168
  s_cselect_b32 s67, 0x400, s31
  s_cmp_ge_u32 s28, 3
  s_mov_b32 s31, 65537
  s_cselect_b32 s31, 65537, s31
  s_bfe_u32 s30, s27, s31
  s_lshl_b32 s31, s30, 6
  v_xor_b32 v164, s31, v164
  v_xor_b32 v165, s31, v165
  s_lshl_b32 s31, s30, 11
  s_add_u32 s40, s40, s31
  s_lshl_b32 s37, s30, 15
  s_mov_b32 s31, -49152
  s_cmp_eq_u32 s30, 0
  s_cselect_b32 s64, 0x4000, s31
  s_mov_b32 s31, -3072
  s_cselect_b32 s65, 0x400, s31
  s_add_u32 s69, s26, s27
  s_and_b32 s69, s69, 3
  s_cmp_ge_u32 s28, 3
  s_cselect_b32 s69, s69, 0
  s_mul_i32 s69, s69, 1
  s_lshl_b32 s70, s69, 7
  s_add_u32 s37, s37, s70
  s_mul_i32 s70, s69, s46
  s_add_u32 s38, s38, s70
  s_mul_i32 s71, s46, -15
  s_movk_i32 s72, 0x80
  s_cmp_ge_u32 s28, 3
  s_cbranch_scc0 L_proj_kernel_ldB
  s_lshl_b32 s30, s24, 4
  v_lshrrev_b32 v1, 1, v0
  v_and_b32 v1, 15, v1
  v_add_u32 v1, s30, v1
  v_lshrrev_b32 v2, 1, v1
  v_and_b32 v2, 4, v2
  v_xor_b32 v1, v1, v2
  v_and_b32 v2, 1, v0
  s_cmp_eq_u32 s28, 3
  s_cselect_b32 s30, 5, 4
  v_lshlrev_b32 v2, s30, v2
  s_cselect_b32 s30, 1, 0
  s_lshr_b32 s39, s39, s30
  v_lshl_add_u32 v176, v1, 6, v2
  v_add_u32 v176, s39, v176
  s_lshl_b32 s39, s69, 12
  s_lshl_b32 s42, s24, 9
  s_add_u32 s42, s42, 49152
  s_branch L_proj_kernel_ldA
L_proj_kernel_ldB:
  s_xor_b32 s30, s26, s27
  s_bitcmp1_b32 s30, 0
  s_cbranch_scc1 L_proj_kernel_ldB1
  s_waitcnt lgkmcnt(0)
  s_lshl_b32 s59, s26, 18
  s_add_u32 s8, s48, s59
  s_addc_u32 s9, s49, 0
  s_and_b32 s9, s9, 0xffff
  s_mov_b32 s10, 262144
  s_mov_b32 s11, 0x20000
  s_add_u32 s12, s50, s47
  s_addc_u32 s13, s51, 0
  s_and_b32 s13, s13, 0xffff
  s_sub_u32 s14, s58, s47
  s_mov_b32 s15, 0x20000
  s_mov_b32 s16, s52
  s_and_b32 s17, s53, 0xffff
  s_mov_b32 s18, 65536
  s_mov_b32 s19, 0x20000
  s_add_u32 m0, s36, s40
  s_mov_b32 s30, s37
  buffer_load_dwordx4 v164, s[8:11], s30 offen  lds
  s_add_u32 m0, m0, 1024
  s_add_u32 s30, s30, 16384
  buffer_load_dwordx4 v165, s[8:11], s30 offen  lds
  s_add_u32 m0, m0, s65
  s_add_u32 s30, s30, s64
  buffer_load_dwordx4 v165, s[8:11], s30 offen  lds
  s_add_u32 m0, m0, 1024
  s_add_u32 s30, s30, 16384
  buffer_load_dwordx4 v164, s[8:11], s30 offen  lds
  s_add_u32 m0, s36, s41
  s_mov_b32 s30, s38
  buffer_load_dwordx4 v168, s[12:15], s30 offen  lds
  s_add_u32 m0, m0, 1024
  s_add_u32 s30, s30, s33
  buffer_load_dwordx4 v169, s[12:15], s30 offen  lds
  s_add_u32 m0, m0, 1024
  s_add_u32 s30, s30, s33
  buffer_load_dwordx4 v168, s[12:15], s30 offen  lds
  s_add_u32 m0, m0, 1024
  s_add_u32 s30, s30, s33
  buffer_load_dwordx4 v169, s[12:15], s30 offen  lds
  s_add_u32 m0, m0, s67
  s_add_u32 s30, s30, s66
  buffer_load_dwordx4 v170, s[12:15], s30 offen  lds
  s_add_u32 m0, m0, 1024
  s_add_u32 s30, s30, s33
  buffer_load_dwordx4 v171, s[12:15], s30 offen  lds
  s_add_u32 m0, m0, 1024
  s_add_u32 s30, s30, s33
  buffer_load_dwordx4 v170, s[12:15], s30 offen  lds
  s_add_u32 m0, m0, 1024
  s_add_u32 s30, s30, s33
  buffer_load_dwordx4 v171, s[12:15], s30 offen  lds
  s_add_u32 s69, s69, 1
  s_cmp_eq_u32 s69, 16
  s_cselect_b32 s69, 0, s69
  s_cselect_b32 s70, s71, s46
  s_add_u32 s38, s38, s70
  s_cmp_eq_u32 s69, 0
  s_cselect_b32 s70, 0xfffff880, s72
  s_add_u32 s37, s37, s70
  s_add_u32 s36, s36, 51200
  s_cmp_eq_u32 s36, 153600
  s_cselect_b32 s36, 0, s36
  s_waitcnt vmcnt(0)
  s_barrier
  s_add_u32 m0, s36, s40
  s_mov_b32 s30, s37
  buffer_load_dwordx4 v164, s[8:11], s30 offen  lds
  s_add_u32 m0, m0, 1024
  s_add_u32 s30, s30, 16384
  buffer_load_dwordx4 v165, s[8:11], s30 offen  lds
  s_add_u32 m0, m0, s65
  s_add_u32 s30, s30, s64
  buffer_load_dwordx4 v165, s[8:11], s30 offen  lds
  s_add_u32 m0, m0, 1024
  s_add_u32 s30, s30, 16384
  buffer_load_dwordx4 v164, s[8:11], s30 offen  lds
  s_add_u32 m0, s36, s41
  s_mov_b32 s30, s38
  buffer_load_dwordx4 v168, s[12:15], s30 offen  lds
  s_add_u32 m0, m0, 1024
  s_add_u32 s30, s30, s33
  buffer_load_dwordx4 v169, s[12:15], s30 offen  lds
  s_add_u32 m0, m0, 1024
  s_add_u32 s30, s30, s33
  buffer_load_dwordx4 v168, s[12:15], s30 offen  lds
  s_add_u32 m0, m0, 1024
  s_add_u32 s30, s30, s33
  buffer_load_dwordx4 v169, s[12:15], s30 offen  lds
  s_add_u32 m0, m0, s67
  s_add_u32 s30, s30, s66
  buffer_load_dwordx4 v170, s[12:15], s30 offen  lds
  s_add_u32 m0, m0, 1024
  s_add_u32 s30, s30, s33
  buffer_load_dwordx4 v171, s[12:15], s30 offen  lds
  s_add_u32 m0, m0, 1024
  s_add_u32 s30, s30, s33
  buffer_load_dwordx4 v170, s[12:15], s30 offen  lds
  s_add_u32 m0, m0, 1024
  s_add_u32 s30, s30, s33
  buffer_load_dwordx4 v171, s[12:15], s30 offen  lds
  s_add_u32 s69, s69, 1
  s_cmp_eq_u32 s69, 16
  s_cselect_b32 s69, 0, s69
  s_cselect_b32 s70, s71, s46
  s_add_u32 s38, s38, s70
  s_cmp_eq_u32 s69, 0
  s_cselect_b32 s70, 0xfffff880, s72
  s_add_u32 s37, s37, s70
  s_add_u32 s36, s36, 51200
  s_cmp_eq_u32 s36, 153600
  s_cselect_b32 s36, 0, s36
  s_add_u32 m0, s36, s40
  s_mov_b32 s30, s37
  buffer_load_dwordx4 v164, s[8:11], s30 offen  lds
  s_add_u32 m0, m0, 1024
  s_add_u32 s30, s30, 16384
  buffer_load_dwordx4 v165, s[8:11], s30 offen  lds
  s_add_u32 m0, m0, s65
  s_add_u32 s30, s30, s64
  buffer_load_dwordx4 v165, s[8:11], s30 offen  lds
  s_add_u32 m0, m0, 1024
  s_add_u32 s30, s30, 16384
  buffer_load_dwordx4 v164, s[8:11], s30 offen  lds
  s_add_u32 m0, s36, s41
  s_mov_b32 s30, s38
  buffer_load_dwordx4 v168, s[12:15], s30 offen  lds
  s_add_u32 m0, m0, 1024
  s_add_u32 s30, s30, s33
  buffer_load_dwordx4 v169, s[12:15], s30 offen  lds
  s_add_u32 m0, m0, 1024
  s_add_u32 s30, s30, s33
  buffer_load_dwordx4 v168, s[12:15], s30 offen  lds
  s_add_u32 m0, m0, 1024
  s_add_u32 s30, s30, s33
  buffer_load_dwordx4 v169, s[12:15], s30 offen  lds
  s_add_u32 m0, m0, s67
  s_add_u32 s30, s30, s66
  buffer_load_dwordx4 v170, s[12:15], s30 offen  lds
  s_add_u32 m0, m0, 1024
  s_add_u32 s30, s30, s33
  buffer_load_dwordx4 v171, s[12:15], s30 offen  lds
  s_add_u32 m0, m0, 1024
  s_add_u32 s30, s30, s33
  buffer_load_dwordx4 v170, s[12:15], s30 offen  lds
  s_add_u32 m0, m0, 1024
  s_add_u32 s30, s30, s33
  buffer_load_dwordx4 v171, s[12:15], s30 offen  lds
  s_add_u32 s69, s69, 1
  s_cmp_eq_u32 s69, 16
  s_cselect_b32 s69, 0, s69
  s_cselect_b32 s70, s71, s46
  s_add_u32 s38, s38, s70
  s_cmp_eq_u32 s69, 0
  s_cselect_b32 s70, 0xfffff880, s72
  s_add_u32 s37, s37, s70
  s_add_u32 s36, s36, 51200
  s_cmp_eq_u32 s36, 153600
  s_cselect_b32 s36, 0, s36
  s_mov_b32 s34, 13
L_proj_kernel_ldB_loop:
  s_waitcnt vmcnt(12)
  s_barrier
  s_add_u32 m0, s36, s40
  s_mov_b32 s30, s37
  buffer_load_dwordx4 v164, s[8:11], s30 offen  lds
  s_add_u32 m0, m0, 1024
  s_add_u32 s30, s30, 16384
  buffer_load_dwordx4 v165, s[8:11], s30 offen  lds
  s_add_u32 m0, m0, s65
  s_add_u32 s30, s30, s64
  buffer_load_dwordx4 v165, s[8:11], s30 offen  lds
  s_add_u32 m0, m0, 1024
  s_add_u32 s30, s30, 16384
  buffer_load_dwordx4 v164, s[8:11], s30 offen  lds
  s_add_u32 m0, s36, s41
  s_mov_b32 s30, s38
  buffer_load_dwordx4 v168, s[12:15], s30 offen  lds
  s_add_u32 m0, m0, 1024
  s_add_u32 s30, s30, s33
  buffer_load_dwordx4 v169, s[12:15], s30 offen  lds
  s_add_u32 m0, m0, 1024
  s_add_u32 s30, s30, s33
  buffer_load_dwordx4 v168, s[12:15], s30 offen  lds
  s_add_u32 m0, m0, 1024
  s_add_u32 s30, s30, s33
  buffer_load_dwordx4 v169, s[12:15], s30 offen  lds
  s_add_u32 m0, m0, s67
  s_add_u32 s30, s30, s66
  buffer_load_dwordx4 v170, s[12:15], s30 offen  lds
  s_add_u32 m0, m0, 1024
  s_add_u32 s30, s30, s33
  buffer_load_dwordx4 v171, s[12:15], s30 offen  lds
  s_add_u32 m0, m0, 1024
  s_add_u32 s30, s30, s33
  buffer_load_dwordx4 v170, s[12:15], s30 offen  lds
  s_add_u32 m0, m0, 1024
  s_add_u32 s30, s30, s33
  buffer_load_dwordx4 v171, s[12:15], s30 offen  lds
  s_add_u32 s69, s69, 1
  s_cmp_eq_u32 s69, 16
  s_cselect_b32 s69, 0, s69
  s_cselect_b32 s70, s71, s46
  s_add_u32 s38, s38, s70
  s_cmp_eq_u32 s69, 0
  s_cselect_b32 s70, 0xfffff880, s72
  s_add_u32 s37, s37, s70
  s_add_u32 s36, s36, 51200
  s_cmp_eq_u32 s36, 153600
  s_cselect_b32 s36, 0, s36
  s_sub_u32 s34, s34, 1
  s_cmp_lg_u32 s34, 0
  s_cbranch_scc1 L_proj_kernel_ldB_loop
  s_waitcnt vmcnt(12)
  s_barrier
  s_waitcnt vmcnt(0)
  s_barrier
  s_branch L_proj_kernel_lend
L_proj_kernel_ldB1:
  s_waitcnt lgkmcnt(0)
  s_lshl_b32 s59, s26, 18
  s_add_u32 s8, s48, s59
  s_addc_u32 s9, s49, 0
  s_and_b32 s9, s9, 0xffff
  s_mov_b32 s10, 262144
  s_mov_b32 s11, 0x20000
  s_add_u32 s12, s50, s47
  s_addc_u32 s13, s51, 0
  s_and_b32 s13, s13, 0xffff
  s_sub_u32 s14, s58, s47
  s_mov_b32 s15, 0x20000
  s_mov_b32 s16, s52
  s_and_b32 s17, s53, 0xffff
  s_mov_b32 s18, 65536
  s_mov_b32 s19, 0x20000
  s_add_u32 m0, s36, s41
  s_mov_b32 s30, s38
  buffer_load_dwordx4 v168, s[12:15], s30 offen  lds
  s_add_u32 m0, m0, 1024
  s_add_u32 s30, s30, s33
  buffer_load_dwordx4 v169, s[12:15], s30 offen  lds
  s_add_u32 m0, m0, 1024
  s_add_u32 s30, s30, s33
  buffer_load_dwordx4 v168, s[12:15], s30 offen  lds
  s_add_u32 m0, m0, 1024
  s_add_u32 s30, s30, s33
  buffer_load_dwordx4 v169, s[12:15], s30 offen  lds
  s_add_u32 m0, m0, s67
  s_add_u32 s30, s30, s66
  buffer_load_dwordx4 v170, s[12:15], s30 offen  lds
  s_add_u32 m0, m0, 1024
  s_add_u32 s30, s30, s33
  buffer_load_dwordx4 v171, s[12:15], s30 offen  lds
  s_add_u32 m0, m0, 1024
  s_add_u32 s30, s30, s33
  buffer_load_dwordx4 v170, s[12:15], s30 offen  lds
  s_add_u32 m0, m0, 1024
  s_add_u32 s30, s30, s33
  buffer_load_dwordx4 v171, s[12:15], s30 offen  lds
  s_add_u32 m0, s36, s40
  s_mov_b32 s30, s37
  buffer_load_dwordx4 v164, s[8:11], s30 offen  lds
  s_add_u32 m0, m0, 1024
  s_add_u32 s30, s30, 16384
  buffer_load_dwordx4 v165, s[8:11], s30 offen  lds
  s_add_u32 m0, m0, s65
  s_add_u32 s30, s30, s64
  buffer_load_dwordx4 v165, s[8:11], s30 offen  lds
  s_add_u32 m0, m0, 1024
  s_add_u32 s30, s30, 16384
  buffer_load_dwordx4 v164, s[8:11], s30 offen  lds
  s_add_u32 s69, s69, 1
  s_cmp_eq_u32 s69, 16
  s_cselect_b32 s69, 0, s69
  s_cselect_b32 s70, s71, s46
  s_add_u32 s38, s38, s70
  s_cmp_eq_u32 s69, 0
  s_cselect_b32 s70, 0xfffff880, s72
  s_add_u32 s37, s37, s70
  s_add_u32 s36, s36, 51200
  s_cmp_eq_u32 s36, 153600
  s_cselect_b32 s36, 0, s36
  s_waitcnt vmcnt(0)
  s_barrier
  s_add_u32 m0, s36, s41
  s_mov_b32 s30, s38
  buffer_load_dwordx4 v168, s[12:15], s30 offen  lds
  s_add_u32 m0, m0, 1024
  s_add_u32 s30, s30, s33
  buffer_load_dwordx4 v169, s[12:15], s30 offen  lds
  s_add_u32 m0, m0, 1024
  s_add_u32 s30, s30, s33
  buffer_load_dwordx4 v168, s[12:15], s30 offen  lds
  s_add_u32 m0, m0, 1024
  s_add_u32 s30, s30, s33
  buffer_load_dwordx4 v169, s[12:15], s30 offen  lds
  s_add_u32 m0, m0, s67
  s_add_u32 s30, s30, s66
  buffer_load_dwordx4 v170, s[12:15], s30 offen  lds
  s_add_u32 m0, m0, 1024
  s_add_u32 s30, s30, s33
  buffer_load_dwordx4 v171, s[12:15], s30 offen  lds
  s_add_u32 m0, m0, 1024
  s_add_u32 s30, s30, s33
  buffer_load_dwordx4 v170, s[12:15], s30 offen  lds
  s_add_u32 m0, m0, 1024
  s_add_u32 s30, s30, s33
  buffer_load_dwordx4 v171, s[12:15], s30 offen  lds
  s_add_u32 m0, s36, s40
  s_mov_b32 s30, s37
  buffer_load_dwordx4 v164, s[8:11], s30 offen  lds
  s_add_u32 m0, m0, 1024
  s_add_u32 s30, s30, 16384
  buffer_load_dwordx4 v165, s[8:11], s30 offen  lds
  s_add_u32 m0, m0, s65
  s_add_u32 s30, s30, s64
  buffer_load_dwordx4 v165, s[8:11], s30 offen  lds
  s_add_u32 m0, m0, 1024
  s_add_u32 s30, s30, 16384
  buffer_load_dwordx4 v164, s[8:11], s30 offen  lds
  s_add_u32 s69, s69, 1
  s_cmp_eq_u32 s69, 16
  s_cselect_b32 s69, 0, s69
  s_cselect_b32 s70, s71, s46
  s_add_u32 s38, s38, s70
  s_cmp_eq_u32 s69, 0
  s_cselect_b32 s70, 0xfffff880, s72
  s_add_u32 s37, s37, s70
  s_add_u32 s36, s36, 51200
  s_cmp_eq_u32 s36, 153600
  s_cselect_b32 s36, 0, s36
  s_add_u32 m0, s36, s41
  s_mov_b32 s30, s38
  buffer_load_dwordx4 v168, s[12:15], s30 offen  lds
  s_add_u32 m0, m0, 1024
  s_add_u32 s30, s30, s33
  buffer_load_dwordx4 v169, s[12:15], s30 offen  lds
  s_add_u32 m0, m0, 1024
  s_add_u32 s30, s30, s33
  buffer_load_dwordx4 v168, s[12:15], s30 offen  lds
  s_add_u32 m0, m0, 1024
  s_add_u32 s30, s30, s33
  buffer_load_dwordx4 v169, s[12:15], s30 offen  lds
  s_add_u32 m0, m0, s67
  s_add_u32 s30, s30, s66
  buffer_load_dwordx4 v170, s[12:15], s30 offen  lds
  s_add_u32 m0, m0, 1024
  s_add_u32 s30, s30, s33
  buffer_load_dwordx4 v171, s[12:15], s30 offen  lds
  s_add_u32 m0, m0, 1024
  s_add_u32 s30, s30, s33
  buffer_load_dwordx4 v170, s[12:15], s30 offen  lds
  s_add_u32 m0, m0, 1024
  s_add_u32 s30, s30, s33
  buffer_load_dwordx4 v171, s[12:15], s30 offen  lds
  s_add_u32 m0, s36, s40
  s_mov_b32 s30, s37
  buffer_load_dwordx4 v164, s[8:11], s30 offen  lds
  s_add_u32 m0, m0, 1024
  s_add_u32 s30, s30, 16384
  buffer_load_dwordx4 v165, s[8:11], s30 offen  lds
  s_add_u32 m0, m0, s65
  s_add_u32 s30, s30, s64
  buffer_load_dwordx4 v165, s[8:11], s30 offen  lds
  s_add_u32 m0, m0, 1024
  s_add_u32 s30, s30, 16384
  buffer_load_dwordx4 v164, s[8:11], s30 offen  lds
  s_add_u32 s69, s69, 1
  s_cmp_eq_u32 s69, 16
  s_cselect_b32 s69, 0, s69
  s_cselect_b32 s70, s71, s46
  s_add_u32 s38, s38, s70
  s_cmp_eq_u32 s69, 0
  s_cselect_b32 s70, 0xfffff880, s72
  s_add_u32 s37, s37, s70
  s_add_u32 s36, s36, 51200
  s_cmp_eq_u32 s36, 153600
  s_cselect_b32 s36, 0, s36
  s_mov_b32 s34, 13
L_proj_kernel_ldB1_loop:
  s_waitcnt vmcnt(12)
  s_barrier
  s_add_u32 m0, s36, s41
  s_mov_b32 s30, s38
  buffer_load_dwordx4 v168, s[12:15], s30 offen  lds
  s_add_u32 m0, m0, 1024
  s_add_u32 s30, s30, s33
  buffer_load_dwordx4 v169, s[12:15], s30 offen  lds
  s_add_u32 m0, m0, 1024
  s_add_u32 s30, s30, s33
  buffer_load_dwordx4 v168, s[12:15], s30 offen  lds
  s_add_u32 m0, m0, 1024
  s_add_u32 s30, s30, s33
  buffer_load_dwordx4 v169, s[12:15], s30 offen  lds
  s_add_u32 m0, m0, s67
  s_add_u32 s30, s30, s66
  buffer_load_dwordx4 v170, s[12:15], s30 offen  lds
  s_add_u32 m0, m0, 1024
  s_add_u32 s30, s30, s33
  buffer_load_dwordx4 v171, s[12:15], s30 offen  lds
  s_add_u32 m0, m0, 1024
  s_add_u32 s30, s30, s33
  buffer_load_dwordx4 v170, s[12:15], s30 offen  lds
  s_add_u32 m0, m0, 1024
  s_add_u32 s30, s30, s33
  buffer_load_dwordx4 v171, s[12:15], s30 offen  lds
  s_add_u32 m0, s36, s40
  s_mov_b32 s30, s37
  buffer_load_dwordx4 v164, s[8:11], s30 offen  lds
  s_add_u32 m0, m0, 1024
  s_add_u32 s30, s30, 16384
  buffer_load_dwordx4 v165, s[8:11], s30 offen  lds
  s_add_u32 m0, m0, s65
  s_add_u32 s30, s30, s64
  buffer_load_dwordx4 v165, s[8:11], s30 offen  lds
  s_add_u32 m0, m0, 1024
  s_add_u32 s30, s30, 16384
  buffer_load_dwordx4 v164, s[8:11], s30 offen  lds
  s_add_u32 s69, s69, 1
  s_cmp_eq_u32 s69, 16
  s_cselect_b32 s69, 0, s69
  s_cselect_b32 s70, s71, s46
  s_add_u32 s38, s38, s70
  s_cmp_eq_u32 s69, 0
  s_cselect_b32 s70, 0xfffff880, s72
  s_add_u32 s37, s37, s70
  s_add_u32 s36, s36, 51200
  s_cmp_eq_u32 s36, 153600
  s_cselect_b32 s36, 0, s36
  s_sub_u32 s34, s34, 1
  s_cmp_lg_u32 s34, 0
  s_cbranch_scc1 L_proj_kernel_ldB1_loop
  s_waitcnt vmcnt(12)
  s_barrier
  s_waitcnt vmcnt(0)
  s_barrier
  s_branch L_proj_kernel_lend
L_proj_kernel_ldA:
  s_xor_b32 s30, s26, s27
  s_bitcmp1_b32 s30, 0
  s_cbranch_scc1 L_proj_kernel_ldA1
  s_waitcnt lgkmcnt(0)
  s_lshl_b32 s59, s26, 18
  s_add_u32 s8, s48, s59
  s_addc_u32 s9, s49, 0
  s_and_b32 s9, s9, 0xffff
  s_mov_b32 s10, 262144
  s_mov_b32 s11, 0x20000
  s_add_u32 s12, s50, s47
  s_addc_u32 s13, s51, 0
  s_and_b32 s13, s13, 0xffff
  s_sub_u32 s14, s58, s47
  s_mov_b32 s15, 0x20000
  s_mov_b32 s16, s52
  s_and_b32 s17, s53, 0xffff
  s_mov_b32 s18, 65536
  s_mov_b32 s19, 0x20000
  s_add_u32 m0, s36, s40
  s_mov_b32 s30, s37
  buffer_load_dwordx4 v164, s[8:11], s30 offen  lds
  s_add_u32 m0, m0, 1024
  s_add_u32 s30, s30, 16384
  buffer_load_dwordx4 v165, s[8:11], s30 offen  lds
  s_add_u32 m0, m0, s65
  s_add_u32 s30, s30, s64
  buffer_load_dwordx4 v165, s[8:11], s30 offen  lds
  s_add_u32 m0, m0, 1024
  s_add_u32 s30, s30, 16384
  buffer_load_dwordx4 v164, s[8:11], s30 offen  lds
  s_add_u32 m0, s36, s41
  s_mov_b32 s30, s38
  buffer_load_dwordx4 v168, s[12:15], s30 offen  lds
  s_add_u32 m0, m0, 1024
  s_add_u32 s30, s30, s33
  buffer_load_dwordx4 v169, s[12:15], s30 offen  lds
  s_add_u32 m0, m0, 1024
  s_add_u32 s30, s30, s33
  buffer_load_dwordx4 v168, s[12:15], s30 offen  lds
  s_add_u32 m0, m0, 1024
  s_add_u32 s30, s30, s33
  buffer_load_dwordx4 v169, s[12:15], s30 offen  lds
  s_add_u32 m0, m0, s67
  s_add_u32 s30, s30, s66
  buffer_load_dwordx4 v170, s[12:15], s30 offen  lds
  s_add_u32 m0, m0, 1024
  s_add_u32 s30, s30, s33
  buffer_load_dwordx4 v171, s[12:15], s30 offen  lds
  s_add_u32 m0, m0, 1024
  s_add_u32 s30, s30, s33
  buffer_load_dwordx4 v170, s[12:15], s30 offen  lds
  s_add_u32 m0, m0, 1024
  s_add_u32 s30, s30, s33
  buffer_load_dwordx4 v171, s[12:15], s30 offen  lds
  s_add_u32 m0, s36, s42
  s_mov_b32 exec_hi, 0
  buffer_load_dwordx4 v176, s[16:19], s39 offen lds
  s_mov_b32 exec_hi, -1
  s_add_u32 s69, s69, 1
  s_cmp_eq_u32 s69, 16
  s_cselect_b32 s69, 0, s69
  s_cselect_b32 s70, s71, s46
  s_add_u32 s38, s38, s70
  s_cmp_eq_u32 s69, 0
  s_cselect_b32 s70, 0xfffff880, s72
  s_add_u32 s37, s37, s70
  s_lshl_b32 s39, s69, 12
  s_add_u32 s36, s36, 51200
  s_cmp_eq_u32 s36, 153600
  s_cselect_b32 s36, 0, s36
  s_add_u32 m0, s36, s40
  s_mov_b32 s30, s37
  buffer_load_dwordx4 v164, s[8:11], s30 offen  lds
  s_add_u32 m0, m0, 1024
  s_add_u32 s30, s30, 16384
  buffer_load_dwordx4 v165, s[8:11], s30 offen  lds
  s_add_u32 m0, m0, s65
  s_add_u32 s30, s30, s64
  buffer_load_dwordx4 v165, s[8:11], s30 offen  lds
  s_add_u32 m0, m0, 1024
  s_add_u32 s30, s30, 16384
  buffer_load_dwordx4 v164, s[8:11], s30 offen  lds
  s_add_u32 m0, s36, s41
  s_mov_b32 s30, s38
  buffer_load_dwordx4 v168, s[12:15], s30 offen  lds
  s_add_u32 m0, m0, 1024
  s_add_u32 s30, s30, s33
  buffer_load_dwordx4 v169, s[12:15], s30 offen  lds
  s_add_u32 m0, m0, 1024
  s_add_u32 s30, s30, s33
  buffer_load_dwordx4 v168, s[12:15], s30 offen  lds
  s_add_u32 m0, m0, 1024
  s_add_u32 s30, s30, s33
  buffer_load_dwordx4 v169, s[12:15], s30 offen  lds
  s_add_u32 m0, m0, s67
  s_add_u32 s30, s30, s66
  buffer_load_dwordx4 v170, s[12:15], s30 offen  lds
  s_add_u32 m0, m0, 1024
  s_add_u32 s30, s30, s33
  buffer_load_dwordx4 v171, s[12:15], s30 offen  lds
  s_add_u32 m0, m0, 1024
  s_add_u32 s30, s30, s33
  buffer_load_dwordx4 v170, s[12:15], s30 offen  lds
  s_add_u32 m0, m0, 1024
  s_add_u32 s30, s30, s33
  buffer_load_dwordx4 v171, s[12:15], s30 offen  lds
  s_add_u32 m0, s36, s42
  s_mov_b32 exec_hi, 0
  buffer_load_dwordx4 v176, s[16:19], s39 offen lds
  s_mov_b32 exec_hi, -1
  s_add_u32 s69, s69, 1
  s_cmp_eq_u32 s69, 16
  s_cselect_b32 s69, 0, s69
  s_cselect_b32 s70, s71, s46
  s_add_u32 s38, s38, s70
  s_cmp_eq_u32 s69, 0
  s_cselect_b32 s70, 0xfffff880, s72
  s_add_u32 s37, s37, s70
  s_lshl_b32 s39, s69, 12
  s_add_u32 s36, s36, 51200
  s_cmp_eq_u32 s36, 153600
  s_cselect_b32 s36, 0, s36
  s_waitcnt vmcnt(13)
  s_barrier
  s_add_u32 m0, s36, s40
  s_mov_b32 s30, s37
  buffer_load_dwordx4 v164, s[8:11], s30 offen  lds
  s_add_u32 m0, m0, 1024
  s_add_u32 s30, s30, 16384
  buffer_load_dwordx4 v165, s[8:11], s30 offen  lds
  s_add_u32 m0, m0, s65
  s_add_u32 s30, s30, s64
  buffer_load_dwordx4 v165, s[8:11], s30 offen  lds
  s_add_u32 m0, m0, 1024
  s_add_u32 s30, s30, 16384
  buffer_load_dwordx4 v164, s[8:11], s30 offen  lds
  s_add_u32 m0, s36, s41
  s_mov_b32 s30, s38
  buffer_load_dwordx4 v168, s[12:15], s30 offen  lds
  s_add_u32 m0, m0, 1024
  s_add_u32 s30, s30, s33
  buffer_load_dwordx4 v169, s[12:15], s30 offen  lds
  s_add_u32 m0, m0, 1024
  s_add_u32 s30, s30, s33
  buffer_load_dwordx4 v168, s[12:15], s30 offen  lds
  s_add_u32 m0, m0, 1024
  s_add_u32 s30, s30, s33
  buffer_load_dwordx4 v169, s[12:15], s30 offen  lds
  s_add_u32 m0, m0, s67
  s_add_u32 s30, s30, s66
  buffer_load_dwordx4 v170, s[12:15], s30 offen  lds
  s_add_u32 m0, m0, 1024
  s_add_u32 s30, s30, s33
  buffer_load_dwordx4 v171, s[12:15], s30 offen  lds
  s_add_u32 m0, m0, 1024
  s_add_u32 s30, s30, s33
  buffer_load_dwordx4 v170, s[12:15], s30 offen  lds
  s_add_u32 m0, m0, 1024
  s_add_u32 s30, s30, s33
  buffer_load_dwordx4 v171, s[12:15], s30 offen  lds
  s_add_u32 m0, s36, s42
  s_mov_b32 exec_hi, 0
  buffer_load_dwordx4 v176, s[16:19], s39 offen lds
  s_mov_b32 exec_hi, -1
  s_add_u32 s69, s69, 1
  s_cmp_eq_u32 s69, 16
  s_cselect_b32 s69, 0, s69
  s_cselect_b32 s70, s71, s46
  s_add_u32 s38, s38, s70
  s_cmp_eq_u32 s69, 0
  s_cselect_b32 s70, 0xfffff880, s72
  s_add_u32 s37, s37, s70
  s_lshl_b32 s39, s69, 12
  s_add_u32 s36, s36, 51200
  s_cmp_eq_u32 s36, 153600
  s_cselect_b32 s36, 0, s36
  s_mov_b32 s34, 13
L_proj_kernel_ldA_loop:
  s_waitcnt vmcnt(13)
  s_barrier
  s_add_u32 m0, s36, s40
  s_mov_b32 s30, s37
  buffer_load_dwordx4 v164, s[8:11], s30 offen  lds
  s_add_u32 m0, m0, 1024
  s_add_u32 s30, s30, 16384
  buffer_load_dwordx4 v165, s[8:11], s30 offen  lds
  s_add_u32 m0, m0, s65
  s_add_u32 s30, s30, s64
  buffer_load_dwordx4 v165, s[8:11], s30 offen  lds
  s_add_u32 m0, m0, 1024
  s_add_u32 s30, s30, 16384
  buffer_load_dwordx4 v164, s[8:11], s30 offen  lds
  s_add_u32 m0, s36, s41
  s_mov_b32 s30, s38
  buffer_load_dwordx4 v168, s[12:15], s30 offen  lds
  s_add_u32 m0, m0, 1024
  s_add_u32 s30, s30, s33
  buffer_load_dwordx4 v169, s[12:15], s30 offen  lds
  s_add_u32 m0, m0, 1024
  s_add_u32 s30, s30, s33
  buffer_load_dwordx4 v168, s[12:15], s30 offen  lds
  s_add_u32 m0, m0, 1024
  s_add_u32 s30, s30, s33
  buffer_load_dwordx4 v169, s[12:15], s30 offen  lds
  s_add_u32 m0, m0, s67
  s_add_u32 s30, s30, s66
  buffer_load_dwordx4 v170, s[12:15], s30 offen  lds
  s_add_u32 m0, m0, 1024
  s_add_u32 s30, s30, s33
  buffer_load_dwordx4 v171, s[12:15], s30 offen  lds
  s_add_u32 m0, m0, 1024
  s_add_u32 s30, s30, s33
  buffer_load_dwordx4 v170, s[12:15], s30 offen  lds
  s_add_u32 m0, m0, 1024
  s_add_u32 s30, s30, s33
  buffer_load_dwordx4 v171, s[12:15], s30 offen  lds
  s_add_u32 m0, s36, s42
  s_mov_b32 exec_hi, 0
  buffer_load_dwordx4 v176, s[16:19], s39 offen lds
  s_mov_b32 exec_hi, -1
  s_add_u32 s69, s69, 1
  s_cmp_eq_u32 s69, 16
  s_cselect_b32 s69, 0, s69
  s_cselect_b32 s70, s71, s46
  s_add_u32 s38, s38, s70
  s_cmp_eq_u32 s69, 0
  s_cselect_b32 s70, 0xfffff880, s72
  s_add_u32 s37, s37, s70
  s_lshl_b32 s39, s69, 12
  s_add_u32 s36, s36, 51200
  s_cmp_eq_u32 s36, 153600
  s_cselect_b32 s36, 0, s36
  s_sub_u32 s34, s34, 1
  s_cmp_lg_u32 s34, 0
  s_cbranch_scc1 L_proj_kernel_ldA_loop
  s_waitcnt vmcnt(13)
  s_barrier
  s_waitcnt vmcnt(0)
  s_barrier
  s_branch L_proj_kernel_lend
L_proj_kernel_ldA1:
  s_waitcnt lgkmcnt(0)
  s_lshl_b32 s59, s26, 18
  s_add_u32 s8, s48, s59
  s_addc_u32 s9, s49, 0
  s_and_b32 s9, s9, 0xffff
  s_mov_b32 s10, 262144
  s_mov_b32 s11, 0x20000
  s_add_u32 s12, s50, s47
  s_addc_u32 s13, s51, 0
  s_and_b32 s13, s13, 0xffff
  s_sub_u32 s14, s58, s47
  s_mov_b32 s15, 0x20000
  s_mov_b32 s16, s52
  s_and_b32 s17, s53, 0xffff
  s_mov_b32 s18, 65536
  s_mov_b32 s19, 0x20000
  s_add_u32 m0, s36, s41
  s_mov_b32 s30, s38
  buffer_load_dwordx4 v168, s[12:15], s30 offen  lds
  s_add_u32 m0, m0, 1024
  s_add_u32 s30, s30, s33
  buffer_load_dwordx4 v169, s[12:15], s30 offen  lds
  s_add_u32 m0, m0, 1024
  s_add_u32 s30, s30, s33
  buffer_load_dwordx4 v168, s[12:15], s30 offen  lds
  s_add_u32 m0, m0, 1024
  s_add_u32 s30, s30, s33
  buffer_load_dwordx4 v169, s[12:15], s30 offen  lds
  s_add_u32 m0, m0, s67
  s_add_u32 s30, s30, s66
  buffer_load_dwordx4 v170, s[12:15], s30 offen  lds
  s_add_u32 m0, m0, 1024
  s_add_u32 s30, s30, s33
  buffer_load_dwordx4 v171, s[12:15], s30 offen  lds
  s_add_u32 m0, m0, 1024
  s_add_u32 s30, s30, s33
  buffer_load_dwordx4 v170, s[12:15], s30 offen  lds
  s_add_u32 m0, m0, 1024
  s_add_u32 s30, s30, s33
  buffer_load_dwordx4 v171, s[12:15], s30 offen  lds
  s_add_u32 m0, s36, s40
  s_mov_b32 s30, s37
  buffer_load_dwordx4 v164, s[8:11], s30 offen  lds
  s_add_u32 m0, m0, 1024
  s_add_u32 s30, s30, 16384
  buffer_load_dwordx4 v165, s[8:11], s30 offen  lds
  s_add_u32 m0, m0, s65
  s_add_u32 s30, s30, s64
  buffer_load_dwordx4 v165, s[8:11], s30 offen  lds
  s_add_u32 m0, m0, 1024
  s_add_u32 s30, s30, 16384
  buffer_load_dwordx4 v164, s[8:11], s30 offen  lds
  s_add_u32 m0, s36, s42
  s_mov_b32 exec_hi, 0
  buffer_load_dwordx4 v176, s[16:19], s39 offen lds
  s_mov_b32 exec_hi, -1
  s_add_u32 s69, s69, 1
  s_cmp_eq_u32 s69, 16
  s_cselect_b32 s69, 0, s69
  s_cselect_b32 s70, s71, s46
  s_add_u32 s38, s38, s70
  s_cmp_eq_u32 s69, 0
  s_cselect_b32 s70, 0xfffff880, s72
  s_add_u32 s37, s37, s70
  s_lshl_b32 s39, s69, 12
  s_add_u32 s36, s36, 51200
  s_cmp_eq_u32 s36, 153600
  s_cselect_b32 s36, 0, s36
  s_add_u32 m0, s36, s41
  s_mov_b32 s30, s38
  buffer_load_dwordx4 v168, s[12:15], s30 offen  lds
  s_add_u32 m0, m0, 1024
  s_add_u32 s30, s30, s33
  buffer_load_dwordx4 v169, s[12:15], s30 offen  lds
  s_add_u32 m0, m0, 1024
  s_add_u32 s30, s30, s33
  buffer_load_dwordx4 v168, s[12:15], s30 offen  lds
  s_add_u32 m0, m0, 1024
  s_add_u32 s30, s30, s33
  buffer_load_dwordx4 v169, s[12:15], s30 offen  lds
  s_add_u32 m0, m0, s67
  s_add_u32 s30, s30, s66
  buffer_load_dwordx4 v170, s[12:15], s30 offen  lds
  s_add_u32 m0, m0, 1024
  s_add_u32 s30, s30, s33
  buffer_load_dwordx4 v171, s[12:15], s30 offen  lds
  s_add_u32 m0, m0, 1024
  s_add_u32 s30, s30, s33
  buffer_load_dwordx4 v170, s[12:15], s30 offen  lds
  s_add_u32 m0, m0, 1024
  s_add_u32 s30, s30, s33
  buffer_load_dwordx4 v171, s[12:15], s30 offen  lds
  s_add_u32 m0, s36, s40
  s_mov_b32 s30, s37
  buffer_load_dwordx4 v164, s[8:11], s30 offen  lds
  s_add_u32 m0, m0, 1024
  s_add_u32 s30, s30, 16384
  buffer_load_dwordx4 v165, s[8:11], s30 offen  lds
  s_add_u32 m0, m0, s65
  s_add_u32 s30, s30, s64
  buffer_load_dwordx4 v165, s[8:11], s30 offen  lds
  s_add_u32 m0, m0, 1024
  s_add_u32 s30, s30, 16384
  buffer_load_dwordx4 v164, s[8:11], s30 offen  lds
  s_add_u32 m0, s36, s42
  s_mov_b32 exec_hi, 0
  buffer_load_dwordx4 v176, s[16:19], s39 offen lds
  s_mov_b32 exec_hi, -1
  s_add_u32 s69, s69, 1
  s_cmp_eq_u32 s69, 16
  s_cselect_b32 s69, 0, s69
  s_cselect_b32 s70, s71, s46
  s_add_u32 s38, s38, s70
  s_cmp_eq_u32 s69, 0
  s_cselect_b32 s70, 0xfffff880, s72
  s_add_u32 s37, s37, s70
  s_lshl_b32 s39, s69, 12
  s_add_u32 s36, s36, 51200
  s_cmp_eq_u32 s36, 153600
  s_cselect_b32 s36, 0, s36
  s_waitcnt vmcnt(13)
  s_barrier
  s_add_u32 m0, s36, s41
  s_mov_b32 s30, s38
  buffer_load_dwordx4 v168, s[12:15], s30 offen  lds
  s_add_u32 m0, m0, 1024
  s_add_u32 s30, s30, s33
  buffer_load_dwordx4 v169, s[12:15], s30 offen  lds
  s_add_u32 m0, m0, 1024
  s_add_u32 s30, s30, s33
  buffer_load_dwordx4 v168, s[12:15], s30 offen  lds
  s_add_u32 m0, m0, 1024
  s_add_u32 s30, s30, s33
  buffer_load_dwordx4 v169, s[12:15], s30 offen  lds
  s_add_u32 m0, m0, s67
  s_add_u32 s30, s30, s66
  buffer_load_dwordx4 v170, s[12:15], s30 offen  lds
  s_add_u32 m0, m0, 1024
  s_add_u32 s30, s30, s33
  buffer_load_dwordx4 v171, s[12:15], s30 offen  lds
  s_add_u32 m0, m0, 1024
  s_add_u32 s30, s30, s33
  buffer_load_dwordx4 v170, s[12:15], s30 offen  lds
  s_add_u32 m0, m0, 1024
  s_add_u32 s30, s30, s33
  buffer_load_dwordx4 v171, s[12:15], s30 offen  lds
  s_add_u32 m0, s36, s40
  s_mov_b32 s30, s37
  buffer_load_dwordx4 v164, s[8:11], s30 offen  lds
  s_add_u32 m0, m0, 1024
  s_add_u32 s30, s30, 16384
  buffer_load_dwordx4 v165, s[8:11], s30 offen  lds
  s_add_u32 m0, m0, s65
  s_add_u32 s30, s30, s64
  buffer_load_dwordx4 v165, s[8:11], s30 offen  lds
  s_add_u32 m0, m0, 1024
  s_add_u32 s30, s30, 16384
  buffer_load_dwordx4 v164, s[8:11], s30 offen  lds
  s_add_u32 m0, s36, s42
  s_mov_b32 exec_hi, 0
  buffer_load_dwordx4 v176, s[16:19], s39 offen lds
  s_mov_b32 exec_hi, -1
  s_add_u32 s69, s69, 1
  s_cmp_eq_u32 s69, 16
  s_cselect_b32 s69, 0, s69
  s_cselect_b32 s70, s71, s46
  s_add_u32 s38, s38, s70
  s_cmp_eq_u32 s69, 0
  s_cselect_b32 s70, 0xfffff880, s72
  s_add_u32 s37, s37, s70
  s_lshl_b32 s39, s69, 12
  s_add_u32 s36, s36, 51200
  s_cmp_eq_u32 s36, 153600
  s_cselect_b32 s36, 0, s36
  s_mov_b32 s34, 13
L_proj_kernel_ldA1_loop:
  s_waitcnt vmcnt(13)
  s_barrier
  s_add_u32 m0, s36, s41
  s_mov_b32 s30, s38
  buffer_load_dwordx4 v168, s[12:15], s30 offen  lds
  s_add_u32 m0, m0, 1024
  s_add_u32 s30, s30, s33
  buffer_load_dwordx4 v169, s[12:15], s30 offen  lds
  s_add_u32 m0, m0, 1024
  s_add_u32 s30, s30, s33
  buffer_load_dwordx4 v168, s[12:15], s30 offen  lds
  s_add_u32 m0, m0, 1024
  s_add_u32 s30, s30, s33
  buffer_load_dwordx4 v169, s[12:15], s30 offen  lds
  s_add_u32 m0, m0, s67
  s_add_u32 s30, s30, s66
  buffer_load_dwordx4 v170, s[12:15], s30 offen  lds
  s_add_u32 m0, m0, 1024
  s_add_u32 s30, s30, s33
  buffer_load_dwordx4 v171, s[12:15], s30 offen  lds
  s_add_u32 m0, m0, 1024
  s_add_u32 s30, s30, s33
  buffer_load_dwordx4 v170, s[12:15], s30 offen  lds
  s_add_u32 m0, m0, 1024
  s_add_u32 s30, s30, s33
  buffer_load_dwordx4 v171, s[12:15], s30 offen  lds
  s_add_u32 m0, s36, s40
  s_mov_b32 s30, s37
  buffer_load_dwordx4 v164, s[8:11], s30 offen  lds
  s_add_u32 m0, m0, 1024
  s_add_u32 s30, s30, 16384
  buffer_load_dwordx4 v165, s[8:11], s30 offen  lds
  s_add_u32 m0, m0, s65
  s_add_u32 s30, s30, s64
  buffer_load_dwordx4 v165, s[8:11], s30 offen  lds
  s_add_u32 m0, m0, 1024
  s_add_u32 s30, s30, 16384
  buffer_load_dwordx4 v164, s[8:11], s30 offen  lds
  s_add_u32 m0, s36, s42
  s_mov_b32 exec_hi, 0
  buffer_load_dwordx4 v176, s[16:19], s39 offen lds
  s_mov_b32 exec_hi, -1
  s_add_u32 s69, s69, 1
  s_cmp_eq_u32 s69, 16
  s_cselect_b32 s69, 0, s69
  s_cselect_b32 s70, s71, s46
  s_add_u32 s38, s38, s70
  s_cmp_eq_u32 s69, 0
  s_cselect_b32 s70, 0xfffff880, s72
  s_add_u32 s37, s37, s70
  s_lshl_b32 s39, s69, 12
  s_add_u32 s36, s36, 51200
  s_cmp_eq_u32 s36, 153600
  s_cselect_b32 s36, 0, s36
  s_sub_u32 s34, s34, 1
  s_cmp_lg_u32 s34, 0
  s_cbranch_scc1 L_proj_kernel_ldA1_loop
  s_waitcnt vmcnt(13)
  s_barrier
  s_waitcnt vmcnt(0)
  s_barrier
  s_branch L_proj_kernel_lend
L_proj_kernel_compute:
  s_waitcnt lgkmcnt(0)
  s_mov_b32 s20, s54
  s_and_b32 s21, s55, 0xffff
  s_mov_b32 s22, 26214400
  s_mov_b32 s23, 0x20000
  v_mov_b32 v24, 0
  s_cmp_lg_u32 s24, 1
  s_cbranch_scc1 L_proj_kernel_notag
  s_cmp_lg_u32 s2, 0
  s_cbranch_scc1 L_proj_kernel_notag
  s_memrealtime s[96:97]
  s_waitcnt lgkmcnt(0)
  s_or_b32 s96, s96, 1
  v_mov_b32 v22, s96
  v_mov_b32 v23, s97
  s_mov_b64 exec, 1
  global_store_dwordx2 v24, v[22:23], s[98:99] sc0 sc1
  s_mov_b64 exec, -1
L_proj_kernel_notag:
  s_lshr_b32 s30, s2, 3
  s_and_b32 s30, s30, 7
  s_cmp_lg_u32 s24, 3
  s_cbranch_scc1 L_proj_kernel_nocp
  s_getpc_b64 s[74:75]
L_cp_proj_kernel:
  s_sub_u32 s74, s74, L_cp_proj_kernel-fused_kernel
  s_subb_u32 s75, s75, 0
  v_lshlrev_b32 v1, 7, v0
  v_lshl_add_u32 v1, s30, 13, v1
  v_min_u32 v1, L_code_end-fused_kernel-4, v1
  global_load_dword v17, v1, s[74:75]
L_proj_kernel_nocp:
  v_and_b32 v1, 15, v0
  v_lshrrev_b32 v2, 4, v0
  v_lshlrev_b32 v16, 9, v2
  v_lshl_add_u32 v16, v1, 4, v16
  v_lshrrev_b32 v3, 1, v1
  v_xor_b32 v3, v3, v2
  v_lshlrev_b32 v3, 4, v3
  v_lshl_add_u32 v4, v1, 7, v3
  v_and_b32 v3, 7, v1
  v_lshrrev_b32 v5, 1, v3
  v_xor_b32 v5, v5, v2
  v_lshlrev_b32 v3, 7, v3
  v_lshrrev_b32 v13, 3, v1
  v_lshlrev_b32 v12, 2, v13
  v_xor_b32 v5, v5, v12
  v_lshl_add_u32 v3, v5, 4, v3
  v_lshl_add_u32 v5, v13, 11, v3
  s_lshl_b32 s30, s24, 12
  s_cmp_eq_u32 s28, 2
  s_cbranch_scc1 L_proj_kernel_xperm
  v_mov_b32 v6, v4
  s_branch L_proj_kernel_xdone
L_proj_kernel_xperm:
  v_mov_b32 v6, v5
L_proj_kernel_xdone:
  v_xor_b32 v7, 64, v6
  s_cmp_eq_u32 s28, 4
  s_cbranch_scc1 L_proj_kernel_eperm
  v_add_u32 v12, s30, v4
  s_branch L_proj_kernel_edone
L_proj_kernel_eperm:
  v_add_u32 v12, s30, v5
L_proj_kernel_edone:
  v_xor_b32 v13, 64, v12
  v_lshrrev_b32 v3, 2, v1
  v_and_b32 v4, 1, v2
  v_lshl_or_b32 v4, v4, 2, v3
  v_lshlrev_b32 v4, 1, v4
  v_lshl_add_u32 v3, v2, 3, v3
  v_lshlrev_b32 v5, 9, v3
  v_and_b32 v15, 1, v1
  v_lshl_add_u32 v5, v15, 3, v5
  v_add_u32 v5, 16384, v5
  v_bfe_u32 v15, v1, 1, 1
  s_lshl_b32 s31, s24, 3
  v_add_u32 v15, s31, v15
  v_add_u32 v8, 0, v15
  v_xor_b32 v8, v8, v4
  v_lshl_add_u32 v8, v8, 4, v5
  v_add_u32 v9, 2, v15
  v_xor_b32 v9, v9, v4
  v_lshl_add_u32 v9, v9, 4, v5
  v_add_u32 v10, 4, v15
  v_xor_b32 v10, v10, v4
  v_lshl_add_u32 v10, v10, 4, v5
  v_add_u32 v11, 6, v15
  v_xor_b32 v11, v11, v4
  v_lshl_add_u32 v11, v11, 4, v5
  v_lshlrev_b32 v5, 5, v3
  v_and_b32 v3, 3, v1
  v_lshl_add_u32 v5, v3, 3, v5
  v_add_u32 v5, 49152, v5
  v_and_b32 v3, 1, v2
  v_lshl_add_u32 v14, v3, 7, v5
  v_xor_b32 v3, 1, v3
  v_lshl_add_u32 v15, v3, 7, v5
  s_mov_b32 s56, 1048744942
  s_mov_b32 s45, 4294864896
  v_mov_b32 v28, 0
  v_mov_b32 v29, 0
  v_mov_b32 v30, 0
  v_mov_b32 v31, 0
  v_mov_b32 v32, 0
  v_mov_b32 v33, 0
  v_mov_b32 v34, 0
  v_mov_b32 v35, 0
  v_mov_b32 v36, 0
  v_mov_b32 v37, 0
  v_mov_b32 v38, 0
  v_mov_b32 v39, 0
  v_mov_b32 v40, 0
  v_mov_b32 v41, 0
  v_mov_b32 v42, 0
  v_mov_b32 v43, 0
  v_mov_b32 v44, 0
  v_mov_b32 v45, 0
  v_mov_b32 v46, 0
  v_mov_b32 v47, 0
  v_mov_b32 v48, 0
  v_mov_b32 v49, 0
  v_mov_b32 v50, 0
  v_mov_b32 v51, 0
  v_mov_b32 v52, 0
  v_mov_b32 v53, 0
  v_mov_b32 v54, 0
  v_mov_b32 v55, 0
  v_mov_b32 v56, 0
  v_mov_b32 v57, 0
  v_mov_b32 v58, 0
  v_mov_b32 v59, 0
  v_mov_b32 v60, 0
  v_mov_b32 v61, 0
  v_mov_b32 v62, 0
  v_mov_b32 v63, 0
  v_mov_b32 v64, 0
  v_mov_b32 v65, 0
  v_mov_b32 v66, 0
  v_mov_b32 v67, 0
  v_mov_b32 v68, 0
  v_mov_b32 v69, 0
  v_mov_b32 v70, 0
  v_mov_b32 v71, 0
  v_mov_b32 v72, 0
  v_mov_b32 v73, 0
  v_mov_b32 v74, 0
  v_mov_b32 v75, 0
  v_mov_b32 v76, 0
  v_mov_b32 v77, 0
  v_mov_b32 v78, 0
  v_mov_b32 v79, 0
  v_mov_b32 v80, 0
  v_mov_b32 v81, 0
  v_mov_b32 v82, 0
  v_mov_b32 v83, 0
  v_mov_b32 v84, 0
  v_mov_b32 v85, 0
  v_mov_b32 v86, 0
  v_mov_b32 v87, 0
  v_mov_b32 v88, 0
  v_mov_b32 v89, 0
  v_mov_b32 v90, 0
  v_mov_b32 v91, 0
  v_mov_b32 v92, 0
  v_mov_b32 v93, 0
  v_mov_b32 v94, 0
  v_mov_b32 v95, 0
  v_mov_b32 v96, 0
  v_mov_b32 v97, 0
  v_mov_b32 v98, 0
  v_mov_b32 v99, 0
  v_mov_b32 v100, 0
  v_mov_b32 v101, 0
  v_mov_b32 v102, 0
  v_mov_b32 v103, 0
  v_mov_b32 v104, 0
  v_mov_b32 v105, 0
  v_mov_b32 v106, 0
  v_mov_b32 v107, 0
  v_mov_b32 v108, 0
  v_mov_b32 v109, 0
  v_mov_b32 v110, 0
  v_mov_b32 v111, 0
  v_mov_b32 v112, 0
  v_mov_b32 v113, 0
  v_mov_b32 v114, 0
  v_mov_b32 v115, 0
  v_mov_b32 v116, 0
  v_mov_b32 v117, 0
  v_mov_b32 v118, 0
  v_mov_b32 v119, 0
  v_mov_b32 v120, 0
  v_mov_b32 v121, 0
  v_mov_b32 v122, 0
  v_mov_b32 v123, 0
  v_mov_b32 v124, 0
  v_mov_b32 v125, 0
  v_mov_b32 v126, 0
  v_mov_b32 v127, 0
  v_mov_b32 v128, 0
  v_mov_b32 v129, 0
  v_mov_b32 v130, 0
  v_mov_b32 v131, 0
  v_mov_b32 v132, 0
  v_mov_b32 v133, 0
  v_mov_b32 v134, 0
  v_mov_b32 v135, 0
  v_mov_b32 v136, 0
  v_mov_b32 v137, 0
  v_mov_b32 v138, 0
  v_mov_b32 v139, 0
  v_mov_b32 v140, 0
  v_mov_b32 v141, 0
  v_mov_b32 v142, 0
  v_mov_b32 v143, 0
  v_mov_b32 v144, 0
  v_mov_b32 v145, 0
  v_mov_b32 v146, 0
  v_mov_b32 v147, 0
  v_mov_b32 v148, 0
  v_mov_b32 v149, 0
  v_mov_b32 v150, 0
  v_mov_b32 v151, 0
  v_mov_b32 v152, 0
  v_mov_b32 v153, 0
  v_mov_b32 v154, 0
  v_mov_b32 v155, 0
  v_mov_b32 v156, 0
  v_mov_b32 v157, 0
  v_mov_b32 v158, 0
  v_mov_b32 v159, 0
  v_mov_b32 v160, 0
  v_mov_b32 v161, 0
  v_mov_b32 v162, 0
  v_mov_b32 v163, 0
  s_mov_b32 s36, 0
  s_barrier
  s_lshl_b32 s30, s27, 3
  s_lshl_b32 s31, s24, 1
  s_add_u32 s30, s30, s31
  s_lshl_b32 s30, s30, 6
  s_lshl_b32 s31, s26, 2
  s_add_u32 s30, s30, s31
  s_add_u32 s31, s31, s24
  s_lshl_b32 s44, s31, 11
  s_add_u32 s44, s44, 16777216
  s_mov_b32 s57, s56
  s_cmp_eq_u32 s28, 0
  s_cbranch_scc1 L_proj_kernel_cBQ
  s_cmp_eq_u32 s28, 1
  s_cbranch_scc1 L_proj_kernel_cBK
  s_cmp_eq_u32 s28, 2
  s_cbranch_scc1 L_proj_kernel_cBV
  s_lshl_b32 s43, s30, 11
  s_add_u32 s43, s43, 0
  s_cmp_eq_u32 s28, 3
  s_cbranch_scc1 L_proj_kernel_cAK
  s_lshl_b32 s31, s39, 3
  s_add_u32 s44, s44, s31
  s_add_u32 s44, s44, 131072
  ds_read_b64_tr_b16 v[208:209], v8 offset:0
  ds_read_b64_tr_b16 v[210:211], v8 offset:2048
  ds_read_b64_tr_b16 v[212:213], v9 offset:0
  ds_read_b64_tr_b16 v[214:215], v9 offset:2048
  ds_read_b64_tr_b16 v[216:217], v10 offset:0
  ds_read_b64_tr_b16 v[218:219], v10 offset:2048
  ds_read_b64_tr_b16 v[220:221], v11 offset:0
  ds_read_b64_tr_b16 v[222:223], v11 offset:2048
  s_waitcnt lgkmcnt(4)
  ds_read_b128 v[164:167], v6 offset:0
  ds_read_b128 v[168:171], v7 offset:2048
  ds_read_b128 v[172:175], v6 offset:4096
  ds_read_b128 v[176:179], v7 offset:6144
  ds_read_b128 v[180:183], v6 offset:8192
  ds_read_b128 v[184:187], v7 offset:10240
  ds_read_b128 v[188:191], v6 offset:12288
  ds_read_b128 v[192:195], v7 offset:14336
  s_waitcnt lgkmcnt(8)
  ds_read_b64_tr_b16 v[248:249], v14 offset:0
  ds_read_b64_tr_b16 v[250:251], v15 offset:0
  ds_read_b128 v[240:243], v12 offset:0
  ds_read_b128 v[244:247], v13 offset:1024
  s_mov_b32 s34, 15
  .p2align 6
L_proj_kernel_av_loop:
  s_waitcnt lgkmcnt(0)
  v_mfma_f32_16x16x32_bf16 v[156:159], v[240:243], v[248:251], v[156:159]
  v_mfma_f32_16x16x32_bf16 v[160:163], v[244:247], v[248:251], v[160:163]
  ds_read_b64_tr_b16 v[248:249], v14 offset:1024
  ds_read_b64_tr_b16 v[250:251], v15 offset:1024
  v_mfma_f32_16x16x32_bf16 v[28:31], v[208:211], v[164:167], v[28:31]
  ds_read_b128 v[240:243], v13 offset:0
  ds_read_b64_tr_b16 v[224:225], v8 offset:16384
  v_mfma_f32_16x16x32_bf16 v[32:35], v[212:215], v[164:167], v[32:35]
  ds_read_b128 v[244:247], v12 offset:1024
  ds_read_b64_tr_b16 v[226:227], v8 offset:18432
  v_mfma_f32_16x16x32_bf16 v[36:39], v[216:219], v[164:167], v[36:39]
  ds_read_b64_tr_b16 v[228:229], v9 offset:16384
  v_mfma_f32_16x16x32_bf16 v[40:43], v[220:223], v[164:167], v[40:43]
  ds_read_b64_tr_b16 v[230:231], v9 offset:18432
  ds_read_b128 v[164:167], v7 offset:0
  v_mfma_f32_16x16x32_bf16 v[44:47], v[208:211], v[168:171], v[44:47]
  ds_read_b64_tr_b16 v[232:233], v10 offset:16384
  v_mfma_f32_16x16x32_bf16 v[48:51], v[212:215], v[168:171], v[48:51]
  ds_read_b64_tr_b16 v[234:235], v10 offset:18432
  v_mfma_f32_16x16x32_bf16 v[52:55], v[216:219], v[168:171], v[52:55]
  ds_read_b64_tr_b16 v[236:237], v11 offset:16384
  v_mfma_f32_16x16x32_bf16 v[56:59], v[220:223], v[168:171], v[56:59]
  ds_read_b64_tr_b16 v[238:239], v11 offset:18432
  ds_read_b128 v[168:171], v6 offset:2048
  v_mfma_f32_16x16x32_bf16 v[60:63], v[208:211], v[172:175], v[60:63]
  ds_read_b128 v[196:199], v6 offset:10240
  v_mfma_f32_16x16x32_bf16 v[64:67], v[212:215], v[172:175], v[64:67]
  ds_read_b128 v[200:203], v7 offset:12288
  v_mfma_f32_16x16x32_bf16 v[68:71], v[216:219], v[172:175], v[68:71]
  ds_read_b128 v[204:207], v6 offset:14336
  v_mfma_f32_16x16x32_bf16 v[72:75], v[220:223], v[172:175], v[72:75]
  ds_read_b128 v[172:175], v7 offset:4096
  v_mfma_f32_16x16x32_bf16 v[76:79], v[208:211], v[176:179], v[76:79]
  s_add_u32 s36, s36, 1
  v_mfma_f32_16x16x32_bf16 v[80:83], v[212:215], v[176:179], v[80:83]
  s_cmp_eq_u32 s36, 3
  v_mfma_f32_16x16x32_bf16 v[84:87], v[216:219], v[176:179], v[84:87]
  s_cselect_b32 s35, s45, 51200
  v_mfma_f32_16x16x32_bf16 v[88:91], v[220:223], v[176:179], v[88:91]
  ds_read_b128 v[176:179], v6 offset:6144
  v_mfma_f32_16x16x32_bf16 v[92:95], v[208:211], v[180:183], v[92:95]
  s_cselect_b32 s36, 0, s36
  v_mfma_f32_16x16x32_bf16 v[96:99], v[212:215], v[180:183], v[96:99]
  v_mfma_f32_16x16x32_bf16 v[100:103], v[216:219], v[180:183], v[100:103]
  v_mfma_f32_16x16x32_bf16 v[104:107], v[220:223], v[180:183], v[104:107]
  ds_read_b128 v[180:183], v7 offset:8192
  v_mfma_f32_16x16x32_bf16 v[108:111], v[208:211], v[184:187], v[108:111]
  v_add_u32 v6, s35, v6
  v_mfma_f32_16x16x32_bf16 v[112:115], v[212:215], v[184:187], v[112:115]
  v_add_u32 v7, s35, v7
  v_mfma_f32_16x16x32_bf16 v[116:119], v[216:219], v[184:187], v[116:119]
  v_add_u32 v8, s35, v8
  v_mfma_f32_16x16x32_bf16 v[120:123], v[220:223], v[184:187], v[120:123]
  v_add_u32 v9, s35, v9
  v_mfma_f32_16x16x32_bf16 v[124:127], v[208:211], v[188:191], v[124:127]
  v_add_u32 v10, s35, v10
  v_mfma_f32_16x16x32_bf16 v[128:131], v[212:215], v[188:191], v[128:131]
  v_add_u32 v11, s35, v11
  v_mfma_f32_16x16x32_bf16 v[132:135], v[216:219], v[188:191], v[132:135]
  v_add_u32 v12, s35, v12
  v_mfma_f32_16x16x32_bf16 v[136:139], v[220:223], v[188:191], v[136:139]
  v_add_u32 v13, s35, v13
  v_mfma_f32_16x16x32_bf16 v[140:143], v[208:211], v[192:195], v[140:143]
  v_add_u32 v14, s35, v14
  v_mfma_f32_16x16x32_bf16 v[144:147], v[212:215], v[192:195], v[144:147]
  v_add_u32 v15, s35, v15
  v_mfma_f32_16x16x32_bf16 v[148:151], v[216:219], v[192:195], v[148:151]
  v_mfma_f32_16x16x32_bf16 v[152:155], v[220:223], v[192:195], v[152:155]
  s_waitcnt lgkmcnt(0)
  s_barrier
  v_mfma_f32_16x16x32_bf16 v[156:159], v[240:243], v[248:251], v[156:159]
  v_mfma_f32_16x16x32_bf16 v[160:163], v[244:247], v[248:251], v[160:163]
  ds_read_b64_tr_b16 v[248:249], v14 offset:0
  ds_read_b64_tr_b16 v[250:251], v15 offset:0
  v_mfma_f32_16x16x32_bf16 v[28:31], v[224:227], v[164:167], v[28:31]
  ds_read_b128 v[240:243], v12 offset:0
  ds_read_b64_tr_b16 v[208:209], v8 offset:0
  v_mfma_f32_16x16x32_bf16 v[32:35], v[228:231], v[164:167], v[32:35]
  ds_read_b128 v[244:247], v13 offset:1024
  ds_read_b64_tr_b16 v[210:211], v8 offset:2048
  v_mfma_f32_16x16x32_bf16 v[36:39], v[232:235], v[164:167], v[36:39]
  ds_read_b64_tr_b16 v[212:213], v9 offset:0
  v_mfma_f32_16x16x32_bf16 v[40:43], v[236:239], v[164:167], v[40:43]
  ds_read_b64_tr_b16 v[214:215], v9 offset:2048
  ds_read_b128 v[164:167], v6 offset:0
  v_mfma_f32_16x16x32_bf16 v[44:47], v[224:227], v[168:171], v[44:47]
  ds_read_b64_tr_b16 v[216:217], v10 offset:0
  v_mfma_f32_16x16x32_bf16 v[48:51], v[228:231], v[168:171], v[48:51]
  ds_read_b64_tr_b16 v[218:219], v10 offset:2048
  v_mfma_f32_16x16x32_bf16 v[52:55], v[232:235], v[168:171], v[52:55]
  ds_read_b64_tr_b16 v[220:221], v11 offset:0
  v_mfma_f32_16x16x32_bf16 v[56:59], v[236:239], v[168:171], v[56:59]
  ds_read_b64_tr_b16 v[222:223], v11 offset:2048
  ds_read_b128 v[168:171], v7 offset:2048
  v_mfma_f32_16x16x32_bf16 v[60:63], v[224:227], v[172:175], v[60:63]
  ds_read_b128 v[184:187], v7 offset:10240
  v_mfma_f32_16x16x32_bf16 v[64:67], v[228:231], v[172:175], v[64:67]
  ds_read_b128 v[188:191], v6 offset:12288
  v_mfma_f32_16x16x32_bf16 v[68:71], v[232:235], v[172:175], v[68:71]
  ds_read_b128 v[192:195], v7 offset:14336
  v_mfma_f32_16x16x32_bf16 v[72:75], v[236:239], v[172:175], v[72:75]
  ds_read_b128 v[172:175], v6 offset:4096
  v_mfma_f32_16x16x32_bf16 v[76:79], v[224:227], v[176:179], v[76:79]
  v_mfma_f32_16x16x32_bf16 v[80:83], v[228:231], v[176:179], v[80:83]
  v_mfma_f32_16x16x32_bf16 v[84:87], v[232:235], v[176:179], v[84:87]
  v_mfma_f32_16x16x32_bf16 v[88:91], v[236:239], v[176:179], v[88:91]
  ds_read_b128 v[176:179], v7 offset:6144
  v_mfma_f32_16x16x32_bf16 v[92:95], v[224:227], v[180:183], v[92:95]
  v_mfma_f32_16x16x32_bf16 v[96:99], v[228:231], v[180:183], v[96:99]
  v_mfma_f32_16x16x32_bf16 v[100:103], v[232:235], v[180:183], v[100:103]
  v_mfma_f32_16x16x32_bf16 v[104:107], v[236:239], v[180:183], v[104:107]
  ds_read_b128 v[180:183], v6 offset:8192
  v_mfma_f32_16x16x32_bf16 v[108:111], v[224:227], v[196:199], v[108:111]
  s_sub_u32 s34, s34, 1
  v_mfma_f32_16x16x32_bf16 v[112:115], v[228:231], v[196:199], v[112:115]
  s_cmp_lg_u32 s34, 0
  v_mfma_f32_16x16x32_bf16 v[116:119], v[232:235], v[196:199], v[116:119]
  v_mfma_f32_16x16x32_bf16 v[120:123], v[236:239], v[196:199], v[120:123]
  v_mfma_f32_16x16x32_bf16 v[124:127], v[224:227], v[200:203], v[124:127]
  v_mfma_f32_16x16x32_bf16 v[128:131], v[228:231], v[200:203], v[128:131]
  v_mfma_f32_16x16x32_bf16 v[132:135], v[232:235], v[200:203], v[132:135]
  v_mfma_f32_16x16x32_bf16 v[136:139], v[236:239], v[200:203], v[136:139]
  v_mfma_f32_16x16x32_bf16 v[140:143], v[224:227], v[204:207], v[140:143]
  v_mfma_f32_16x16x32_bf16 v[144:147], v[228:231], v[204:207], v[144:147]
  v_mfma_f32_16x16x32_bf16 v[148:151], v[232:235], v[204:207], v[148:151]
  v_mfma_f32_16x16x32_bf16 v[152:155], v[236:239], v[204:207], v[152:155]
  s_cbranch_scc1 L_proj_kernel_av_loop
  s_cmp_lg_u32 s3, 0
  s_cbranch_scc1 L_proj_kernel_av_notag
  global_load_dwordx2 v[26:27], v24, s[98:99] sc0 sc1
L_proj_kernel_av_notag:
  s_waitcnt lgkmcnt(0)
  v_mfma_f32_16x16x32_bf16 v[156:159], v[240:243], v[248:251], v[156:159]
  v_mfma_f32_16x16x32_bf16 v[160:163], v[244:247], v[248:251], v[160:163]
  ds_read_b64_tr_b16 v[248:249], v14 offset:1024
  ds_read_b64_tr_b16 v[250:251], v15 offset:1024
  v_mfma_f32_16x16x32_bf16 v[28:31], v[208:211], v[164:167], v[28:31]
  ds_read_b128 v[240:243], v13 offset:0
  ds_read_b64_tr_b16 v[224:225], v8 offset:16384
  v_mfma_f32_16x16x32_bf16 v[32:35], v[212:215], v[164:167], v[32:35]
  ds_read_b128 v[244:247], v12 offset:1024
  ds_read_b64_tr_b16 v[226:227], v8 offset:18432
  v_mfma_f32_16x16x32_bf16 v[36:39], v[216:219], v[164:167], v[36:39]
  ds_read_b64_tr_b16 v[228:229], v9 offset:16384
  v_mfma_f32_16x16x32_bf16 v[40:43], v[220:223], v[164:167], v[40:43]
  ds_read_b64_tr_b16 v[230:231], v9 offset:18432
  ds_read_b128 v[164:167], v7 offset:0
  v_mfma_f32_16x16x32_bf16 v[44:47], v[208:211], v[168:171], v[44:47]
  ds_read_b64_tr_b16 v[232:233], v10 offset:16384
  v_mfma_f32_16x16x32_bf16 v[48:51], v[212:215], v[168:171], v[48:51]
  ds_read_b64_tr_b16 v[234:235], v10 offset:18432
  v_mfma_f32_16x16x32_bf16 v[52:55], v[216:219], v[168:171], v[52:55]
  ds_read_b64_tr_b16 v[236:237], v11 offset:16384
  v_mfma_f32_16x16x32_bf16 v[56:59], v[220:223], v[168:171], v[56:59]
  ds_read_b64_tr_b16 v[238:239], v11 offset:18432
  ds_read_b128 v[168:171], v6 offset:2048
  v_mfma_f32_16x16x32_bf16 v[60:63], v[208:211], v[172:175], v[60:63]
  ds_read_b128 v[196:199], v6 offset:10240
  v_mfma_f32_16x16x32_bf16 v[64:67], v[212:215], v[172:175], v[64:67]
  ds_read_b128 v[200:203], v7 offset:12288
  v_mfma_f32_16x16x32_bf16 v[68:71], v[216:219], v[172:175], v[68:71]
  ds_read_b128 v[204:207], v6 offset:14336
  v_mfma_f32_16x16x32_bf16 v[72:75], v[220:223], v[172:175], v[72:75]
  ds_read_b128 v[172:175], v7 offset:4096
  v_mfma_f32_16x16x32_bf16 v[76:79], v[208:211], v[176:179], v[76:79]
  v_mfma_f32_16x16x32_bf16 v[80:83], v[212:215], v[176:179], v[80:83]
  v_mfma_f32_16x16x32_bf16 v[84:87], v[216:219], v[176:179], v[84:87]
  v_mfma_f32_16x16x32_bf16 v[88:91], v[220:223], v[176:179], v[88:91]
  ds_read_b128 v[176:179], v6 offset:6144
  s_waitcnt lgkmcnt(5)
  v_mfma_f32_16x16x32_bf16 v[156:159], v[240:243], v[248:251], v[156:159]
  v_mfma_f32_16x16x32_bf16 v[160:163], v[244:247], v[248:251], v[160:163]
  v_mfma_f32_16x16x32_bf16 v[28:31], v[224:227], v[164:167], v[28:31]
  v_mfma_f32_16x16x32_bf16 v[32:35], v[228:231], v[164:167], v[32:35]
  v_mfma_f32_16x16x32_bf16 v[36:39], v[232:235], v[164:167], v[36:39]
  v_mfma_f32_16x16x32_bf16 v[40:43], v[236:239], v[164:167], v[40:43]
  v_mfma_f32_16x16x32_bf16 v[44:47], v[224:227], v[168:171], v[44:47]
  v_mfma_f32_16x16x32_bf16 v[48:51], v[228:231], v[168:171], v[48:51]
  v_mfma_f32_16x16x32_bf16 v[52:55], v[232:235], v[168:171], v[52:55]
  v_mfma_f32_16x16x32_bf16 v[56:59], v[236:239], v[168:171], v[56:59]
  s_waitcnt lgkmcnt(1)
  v_mfma_f32_16x16x32_bf16 v[60:63], v[224:227], v[172:175], v[60:63]
  v_mfma_f32_16x16x32_bf16 v[64:67], v[228:231], v[172:175], v[64:67]
  v_mfma_f32_16x16x32_bf16 v[68:71], v[232:235], v[172:175], v[68:71]
  v_mfma_f32_16x16x32_bf16 v[72:75], v[236:239], v[172:175], v[72:75]
  s_waitcnt lgkmcnt(0)
  v_mfma_f32_16x16x32_bf16 v[76:79], v[224:227], v[176:179], v[76:79]
  v_mfma_f32_16x16x32_bf16 v[80:83], v[228:231], v[176:179], v[80:83]
  v_mfma_f32_16x16x32_bf16 v[84:87], v[232:235], v[176:179], v[84:87]
  v_mfma_f32_16x16x32_bf16 v[88:91], v[236:239], v[176:179], v[88:91]
  v_mfma_f32_16x16x32_bf16 v[92:95], v[208:211], v[180:183], v[92:95]
  s_add_u32 s30, s43, 0
  v_pk_mul_f32 v[28:29], v[28:29], s[56:57]
  v_pk_mul_f32 v[30:31], v[30:31], s[56:57]
  v_mfma_f32_16x16x32_bf16 v[96:99], v[212:215], v[180:183], v[96:99]
  v_pk_mul_f32 v[32:33], v[32:33], s[56:57]
  v_pk_mul_f32 v[34:35], v[34:35], s[56:57]
  v_mfma_f32_16x16x32_bf16 v[100:103], v[216:219], v[180:183], v[100:103]
  v_cvt_pk_bf16_f32 v164, v28, v29
  v_cvt_pk_bf16_f32 v165, v30, v31
  v_cvt_pk_bf16_f32 v166, v32, v33
  v_mfma_f32_16x16x32_bf16 v[104:107], v[220:223], v[180:183], v[104:107]
  ds_read_b128 v[180:183], v7 offset:8192
  v_cvt_pk_bf16_f32 v167, v34, v35
  buffer_store_dwordx4 v[164:167], v16, s[20:23], s30 offen offset:0 sc0 sc1
  v_mfma_f32_16x16x32_bf16 v[108:111], v[208:211], v[184:187], v[108:111]
  v_pk_mul_f32 v[44:45], v[44:45], s[56:57]
  v_pk_mul_f32 v[46:47], v[46:47], s[56:57]
  v_mfma_f32_16x16x32_bf16 v[112:115], v[212:215], v[184:187], v[112:115]
  v_pk_mul_f32 v[48:49], v[48:49], s[56:57]
  v_pk_mul_f32 v[50:51], v[50:51], s[56:57]
  v_cvt_pk_bf16_f32 v168, v44, v45
  v_mfma_f32_16x16x32_bf16 v[116:119], v[216:219], v[184:187], v[116:119]
  v_cvt_pk_bf16_f32 v169, v46, v47
  v_cvt_pk_bf16_f32 v170, v48, v49
  v_mfma_f32_16x16x32_bf16 v[120:123], v[220:223], v[184:187], v[120:123]
  v_cvt_pk_bf16_f32 v171, v50, v51
  buffer_store_dwordx4 v[168:171], v16, s[20:23], s30 offen offset:256 sc0 sc1
  v_mfma_f32_16x16x32_bf16 v[124:127], v[208:211], v[188:191], v[124:127]
  s_add_u32 s30, s43, 131072
  v_pk_mul_f32 v[36:37], v[36:37], s[56:57]
  v_pk_mul_f32 v[38:39], v[38:39], s[56:57]
  v_mfma_f32_16x16x32_bf16 v[128:131], v[212:215], v[188:191], v[128:131]
  v_pk_mul_f32 v[40:41], v[40:41], s[56:57]
  v_pk_mul_f32 v[42:43], v[42:43], s[56:57]
  v_mfma_f32_16x16x32_bf16 v[132:135], v[216:219], v[188:191], v[132:135]
  v_cvt_pk_bf16_f32 v172, v36, v37
  v_cvt_pk_bf16_f32 v173, v38, v39
  v_cvt_pk_bf16_f32 v174, v40, v41
  v_mfma_f32_16x16x32_bf16 v[136:139], v[220:223], v[188:191], v[136:139]
  v_cvt_pk_bf16_f32 v175, v42, v43
  buffer_store_dwordx4 v[172:175], v16, s[20:23], s30 offen offset:0 sc0 sc1
  v_mfma_f32_16x16x32_bf16 v[140:143], v[208:211], v[192:195], v[140:143]
  v_pk_mul_f32 v[52:53], v[52:53], s[56:57]
  v_pk_mul_f32 v[54:55], v[54:55], s[56:57]
  v_mfma_f32_16x16x32_bf16 v[144:147], v[212:215], v[192:195], v[144:147]
  v_pk_mul_f32 v[56:57], v[56:57], s[56:57]
  v_pk_mul_f32 v[58:59], v[58:59], s[56:57]
  v_cvt_pk_bf16_f32 v176, v52, v53
  v_mfma_f32_16x16x32_bf16 v[148:151], v[216:219], v[192:195], v[148:151]
  v_cvt_pk_bf16_f32 v177, v54, v55
  v_cvt_pk_bf16_f32 v178, v56, v57
  v_mfma_f32_16x16x32_bf16 v[152:155], v[220:223], v[192:195], v[152:155]
  v_cvt_pk_bf16_f32 v179, v58, v59
  buffer_store_dwordx4 v[176:179], v16, s[20:23], s30 offen offset:256 sc0 sc1
  s_waitcnt lgkmcnt(0)
  v_mfma_f32_16x16x32_bf16 v[92:95], v[224:227], v[180:183], v[92:95]
  s_add_u32 s30, s43, 2048
  v_pk_mul_f32 v[60:61], v[60:61], s[56:57]
  v_pk_mul_f32 v[62:63], v[62:63], s[56:57]
  v_mfma_f32_16x16x32_bf16 v[96:99], v[228:231], v[180:183], v[96:99]
  v_pk_mul_f32 v[64:65], v[64:65], s[56:57]
  v_pk_mul_f32 v[66:67], v[66:67], s[56:57]
  v_mfma_f32_16x16x32_bf16 v[100:103], v[232:235], v[180:183], v[100:103]
  v_cvt_pk_bf16_f32 v164, v60, v61
  v_cvt_pk_bf16_f32 v165, v62, v63
  v_cvt_pk_bf16_f32 v166, v64, v65
  v_mfma_f32_16x16x32_bf16 v[104:107], v[236:239], v[180:183], v[104:107]
  v_cvt_pk_bf16_f32 v167, v66, v67
  buffer_store_dwordx4 v[164:167], v16, s[20:23], s30 offen offset:0 sc0 sc1
  v_mfma_f32_16x16x32_bf16 v[108:111], v[224:227], v[196:199], v[108:111]
  v_pk_mul_f32 v[76:77], v[76:77], s[56:57]
  v_pk_mul_f32 v[78:79], v[78:79], s[56:57]
  v_mfma_f32_16x16x32_bf16 v[112:115], v[228:231], v[196:199], v[112:115]
  v_pk_mul_f32 v[80:81], v[80:81], s[56:57]
  v_pk_mul_f32 v[82:83], v[82:83], s[56:57]
  v_cvt_pk_bf16_f32 v168, v76, v77
  v_mfma_f32_16x16x32_bf16 v[116:119], v[232:235], v[196:199], v[116:119]
  v_cvt_pk_bf16_f32 v169, v78, v79
  v_cvt_pk_bf16_f32 v170, v80, v81
  v_mfma_f32_16x16x32_bf16 v[120:123], v[236:239], v[196:199], v[120:123]
  v_cvt_pk_bf16_f32 v171, v82, v83
  buffer_store_dwordx4 v[168:171], v16, s[20:23], s30 offen offset:256 sc0 sc1
  v_mfma_f32_16x16x32_bf16 v[124:127], v[224:227], v[200:203], v[124:127]
  s_add_u32 s30, s43, 133120
  v_pk_mul_f32 v[68:69], v[68:69], s[56:57]
  v_pk_mul_f32 v[70:71], v[70:71], s[56:57]
  v_mfma_f32_16x16x32_bf16 v[128:131], v[228:231], v[200:203], v[128:131]
  v_pk_mul_f32 v[72:73], v[72:73], s[56:57]
  v_pk_mul_f32 v[74:75], v[74:75], s[56:57]
  v_mfma_f32_16x16x32_bf16 v[132:135], v[232:235], v[200:203], v[132:135]
  v_cvt_pk_bf16_f32 v172, v68, v69
  v_cvt_pk_bf16_f32 v173, v70, v71
  v_cvt_pk_bf16_f32 v174, v72, v73
  v_mfma_f32_16x16x32_bf16 v[136:139], v[236:239], v[200:203], v[136:139]
  v_cvt_pk_bf16_f32 v175, v74, v75
  buffer_store_dwordx4 v[172:175], v16, s[20:23], s30 offen offset:0 sc0 sc1
  v_mfma_f32_16x16x32_bf16 v[140:143], v[224:227], v[204:207], v[140:143]
  v_pk_mul_f32 v[84:85], v[84:85], s[56:57]
  v_pk_mul_f32 v[86:87], v[86:87], s[56:57]
  v_mfma_f32_16x16x32_bf16 v[144:147], v[228:231], v[204:207], v[144:147]
  v_pk_mul_f32 v[88:89], v[88:89], s[56:57]
  v_pk_mul_f32 v[90:91], v[90:91], s[56:57]
  v_cvt_pk_bf16_f32 v176, v84, v85
  v_mfma_f32_16x16x32_bf16 v[148:151], v[232:235], v[204:207], v[148:151]
  v_cvt_pk_bf16_f32 v177, v86, v87
  v_cvt_pk_bf16_f32 v178, v88, v89
  v_mfma_f32_16x16x32_bf16 v[152:155], v[236:239], v[204:207], v[152:155]
  v_cvt_pk_bf16_f32 v179, v90, v91
  buffer_store_dwordx4 v[176:179], v16, s[20:23], s30 offen offset:256 sc0 sc1
  s_nop 7
  s_add_u32 s30, s43, 4096
  v_pk_mul_f32 v[92:93], v[92:93], s[56:57]
  v_pk_mul_f32 v[94:95], v[94:95], s[56:57]
  v_pk_mul_f32 v[96:97], v[96:97], s[56:57]
  v_pk_mul_f32 v[98:99], v[98:99], s[56:57]
  v_cvt_pk_bf16_f32 v164, v92, v93
  v_cvt_pk_bf16_f32 v165, v94, v95
  v_cvt_pk_bf16_f32 v166, v96, v97
  v_cvt_pk_bf16_f32 v167, v98, v99
  buffer_store_dwordx4 v[164:167], v16, s[20:23], s30 offen offset:0 sc0 sc1
  v_pk_mul_f32 v[108:109], v[108:109], s[56:57]
  v_pk_mul_f32 v[110:111], v[110:111], s[56:57]
  v_pk_mul_f32 v[112:113], v[112:113], s[56:57]
  v_pk_mul_f32 v[114:115], v[114:115], s[56:57]
  v_cvt_pk_bf16_f32 v168, v108, v109
  v_cvt_pk_bf16_f32 v169, v110, v111
  v_cvt_pk_bf16_f32 v170, v112, v113
  v_cvt_pk_bf16_f32 v171, v114, v115
  buffer_store_dwordx4 v[168:171], v16, s[20:23], s30 offen offset:256 sc0 sc1
  s_add_u32 s30, s43, 135168
  v_pk_mul_f32 v[100:101], v[100:101], s[56:57]
  v_pk_mul_f32 v[102:103], v[102:103], s[56:57]
  v_pk_mul_f32 v[104:105], v[104:105], s[56:57]
  v_pk_mul_f32 v[106:107], v[106:107], s[56:57]
  v_cvt_pk_bf16_f32 v172, v100, v101
  v_cvt_pk_bf16_f32 v173, v102, v103
  v_cvt_pk_bf16_f32 v174, v104, v105
  v_cvt_pk_bf16_f32 v175, v106, v107
  buffer_store_dwordx4 v[172:175], v16, s[20:23], s30 offen offset:0 sc0 sc1
  v_pk_mul_f32 v[116:117], v[116:117], s[56:57]
  v_pk_mul_f32 v[118:119], v[118:119], s[56:57]
  v_pk_mul_f32 v[120:121], v[120:121], s[56:57]
  v_pk_mul_f32 v[122:123], v[122:123], s[56:57]
  v_cvt_pk_bf16_f32 v176, v116, v117
  v_cvt_pk_bf16_f32 v177, v118, v119
  v_cvt_pk_bf16_f32 v178, v120, v121
  v_cvt_pk_bf16_f32 v179, v122, v123
  buffer_store_dwordx4 v[176:179], v16, s[20:23], s30 offen offset:256 sc0 sc1
  s_add_u32 s30, s43, 6144
  v_pk_mul_f32 v[124:125], v[124:125], s[56:57]
  v_pk_mul_f32 v[126:127], v[126:127], s[56:57]
  v_pk_mul_f32 v[128:129], v[128:129], s[56:57]
  v_pk_mul_f32 v[130:131], v[130:131], s[56:57]
  v_cvt_pk_bf16_f32 v164, v124, v125
  v_cvt_pk_bf16_f32 v165, v126, v127
  v_cvt_pk_bf16_f32 v166, v128, v129
  v_cvt_pk_bf16_f32 v167, v130, v131
  buffer_store_dwordx4 v[164:167], v16, s[20:23], s30 offen offset:0 sc0 sc1
  v_pk_mul_f32 v[140:141], v[140:141], s[56:57]
  v_pk_mul_f32 v[142:143], v[142:143], s[56:57]
  v_pk_mul_f32 v[144:145], v[144:145], s[56:57]
  v_pk_mul_f32 v[146:147], v[146:147], s[56:57]
  v_cvt_pk_bf16_f32 v168, v140, v141
  v_cvt_pk_bf16_f32 v169, v142, v143
  v_cvt_pk_bf16_f32 v170, v144, v145
  v_cvt_pk_bf16_f32 v171, v146, v147
  buffer_store_dwordx4 v[168:171], v16, s[20:23], s30 offen offset:256 sc0 sc1
  s_add_u32 s30, s43, 137216
  v_pk_mul_f32 v[132:133], v[132:133], s[56:57]
  v_pk_mul_f32 v[134:135], v[134:135], s[56:57]
  v_pk_mul_f32 v[136:137], v[136:137], s[56:57]
  v_pk_mul_f32 v[138:139], v[138:139], s[56:57]
  v_cvt_pk_bf16_f32 v172, v132, v133
  v_cvt_pk_bf16_f32 v173, v134, v135
  v_cvt_pk_bf16_f32 v174, v136, v137
  v_cvt_pk_bf16_f32 v175, v138, v139
  buffer_store_dwordx4 v[172:175], v16, s[20:23], s30 offen offset:0 sc0 sc1
  v_pk_mul_f32 v[148:149], v[148:149], s[56:57]
  v_pk_mul_f32 v[150:151], v[150:151], s[56:57]
  v_pk_mul_f32 v[152:153], v[152:153], s[56:57]
  v_pk_mul_f32 v[154:155], v[154:155], s[56:57]
  v_cvt_pk_bf16_f32 v176, v148, v149
  v_cvt_pk_bf16_f32 v177, v150, v151
  v_cvt_pk_bf16_f32 v178, v152, v153
  v_cvt_pk_bf16_f32 v179, v154, v155
  buffer_store_dwordx4 v[176:179], v16, s[20:23], s30 offen offset:256 sc0 sc1
  v_cvt_pk_bf16_f32 v208, v156, v157
  v_cvt_pk_bf16_f32 v209, v158, v159
  v_cvt_pk_bf16_f32 v210, v160, v161
  v_cvt_pk_bf16_f32 v211, v162, v163
  buffer_store_dwordx4 v[208:211], v16, s[20:23], s44 offen sc0 sc1
  s_branch L_proj_kernel_done
L_proj_kernel_cAK:
  s_lshl_b32 s31, s39, 5
  s_add_u32 s44, s44, s31
  ds_read_b64_tr_b16 v[208:209], v8 offset:0
  ds_read_b64_tr_b16 v[210:211], v8 offset:2048
  ds_read_b64_tr_b16 v[212:213], v9 offset:0
  ds_read_b64_tr_b16 v[214:215], v9 offset:2048
  ds_read_b64_tr_b16 v[216:217], v10 offset:0
  ds_read_b64_tr_b16 v[218:219], v10 offset:2048
  ds_read_b64_tr_b16 v[220:221], v11 offset:0
  ds_read_b64_tr_b16 v[222:223], v11 offset:2048
  s_waitcnt lgkmcnt(4)
  ds_read_b128 v[164:167], v6 offset:0
  ds_read_b128 v[168:171], v7 offset:2048
  ds_read_b128 v[172:175], v6 offset:4096
  ds_read_b128 v[176:179], v7 offset:6144
  ds_read_b128 v[180:183], v6 offset:8192
  ds_read_b128 v[184:187], v7 offset:10240
  ds_read_b128 v[188:191], v6 offset:12288
  ds_read_b128 v[192:195], v7 offset:14336
  s_waitcnt lgkmcnt(8)
  ds_read_b64_tr_b16 v[248:249], v14 offset:0
  ds_read_b64_tr_b16 v[250:251], v15 offset:0
  ds_read_b128 v[240:243], v12 offset:0
  ds_read_b128 v[244:247], v13 offset:2048
  s_mov_b32 s34, 15
  .p2align 6
L_proj_kernel_ak_loop:
  s_waitcnt lgkmcnt(0)
  v_mfma_f32_16x16x32_bf16 v[156:159], v[248:251], v[240:243], v[156:159]
  v_mfma_f32_16x16x32_bf16 v[160:163], v[248:251], v[244:247], v[160:163]
  ds_read_b64_tr_b16 v[248:249], v14 offset:1024
  ds_read_b64_tr_b16 v[250:251], v15 offset:1024
  v_mfma_f32_16x16x32_bf16 v[28:31], v[208:211], v[164:167], v[28:31]
  ds_read_b128 v[240:243], v13 offset:0
  ds_read_b64_tr_b16 v[224:225], v8 offset:16384
  v_mfma_f32_16x16x32_bf16 v[32:35], v[212:215], v[164:167], v[32:35]
  ds_read_b128 v[244:247], v12 offset:2048
  ds_read_b64_tr_b16 v[226:227], v8 offset:18432
  v_mfma_f32_16x16x32_bf16 v[36:39], v[216:219], v[164:167], v[36:39]
  ds_read_b64_tr_b16 v[228:229], v9 offset:16384
  v_mfma_f32_16x16x32_bf16 v[40:43], v[220:223], v[164:167], v[40:43]
  ds_read_b64_tr_b16 v[230:231], v9 offset:18432
  ds_read_b128 v[164:167], v7 offset:0
  v_mfma_f32_16x16x32_bf16 v[44:47], v[208:211], v[168:171], v[44:47]
  ds_read_b64_tr_b16 v[232:233], v10 offset:16384
  v_mfma_f32_16x16x32_bf16 v[48:51], v[212:215], v[168:171], v[48:51]
  ds_read_b64_tr_b16 v[234:235], v10 offset:18432
  v_mfma_f32_16x16x32_bf16 v[52:55], v[216:219], v[168:171], v[52:55]
  ds_read_b64_tr_b16 v[236:237], v11 offset:16384
  v_mfma_f32_16x16x32_bf16 v[56:59], v[220:223], v[168:171], v[56:59]
  ds_read_b64_tr_b16 v[238:239], v11 offset:18432
  ds_read_b128 v[168:171], v6 offset:2048
  v_mfma_f32_16x16x32_bf16 v[60:63], v[208:211], v[172:175], v[60:63]
  ds_read_b128 v[196:199], v6 offset:10240
  v_mfma_f32_16x16x32_bf16 v[64:67], v[212:215], v[172:175], v[64:67]
  ds_read_b128 v[200:203], v7 offset:12288
  v_mfma_f32_16x16x32_bf16 v[68:71], v[216:219], v[172:175], v[68:71]
  ds_read_b128 v[204:207], v6 offset:14336
  v_mfma_f32_16x16x32_bf16 v[72:75], v[220:223], v[172:175], v[72:75]
  ds_read_b128 v[172:175], v7 offset:4096
  v_mfma_f32_16x16x32_bf16 v[76:79], v[208:211], v[176:179], v[76:79]
  s_add_u32 s36, s36, 1
  v_mfma_f32_16x16x32_bf16 v[80:83], v[212:215], v[176:179], v[80:83]
  s_cmp_eq_u32 s36, 3
  v_mfma_f32_16x16x32_bf16 v[84:87], v[216:219], v[176:179], v[84:87]
  s_cselect_b32 s35, s45, 51200
  v_mfma_f32_16x16x32_bf16 v[88:91], v[220:223], v[176:179], v[88:91]
  ds_read_b128 v[176:179], v6 offset:6144
  v_mfma_f32_16x16x32_bf16 v[92:95], v[208:211], v[180:183], v[92:95]
  s_cselect_b32 s36, 0, s36
  v_mfma_f32_16x16x32_bf16 v[96:99], v[212:215], v[180:183], v[96:99]
  v_mfma_f32_16x16x32_bf16 v[100:103], v[216:219], v[180:183], v[100:103]
  v_mfma_f32_16x16x32_bf16 v[104:107], v[220:223], v[180:183], v[104:107]
  ds_read_b128 v[180:183], v7 offset:8192
  v_mfma_f32_16x16x32_bf16 v[108:111], v[208:211], v[184:187], v[108:111]
  v_add_u32 v6, s35, v6
  v_mfma_f32_16x16x32_bf16 v[112:115], v[212:215], v[184:187], v[112:115]
  v_add_u32 v7, s35, v7
  v_mfma_f32_16x16x32_bf16 v[116:119], v[216:219], v[184:187], v[116:119]
  v_add_u32 v8, s35, v8
  v_mfma_f32_16x16x32_bf16 v[120:123], v[220:223], v[184:187], v[120:123]
  v_add_u32 v9, s35, v9
  v_mfma_f32_16x16x32_bf16 v[124:127], v[208:211], v[188:191], v[124:127]
  v_add_u32 v10, s35, v10
  v_mfma_f32_16x16x32_bf16 v[128:131], v[212:215], v[188:191], v[128:131]
  v_add_u32 v11, s35, v11
  v_mfma_f32_16x16x32_bf16 v[132:135], v[216:219], v[188:191], v[132:135]
  v_add_u32 v12, s35, v12
  v_mfma_f32_16x16x32_bf16 v[136:139], v[220:223], v[188:191], v[136:139]
  v_add_u32 v13, s35, v13
  v_mfma_f32_16x16x32_bf16 v[140:143], v[208:211], v[192:195], v[140:143]
  v_add_u32 v14, s35, v14
  v_mfma_f32_16x16x32_bf16 v[144:147], v[212:215], v[192:195], v[144:147]
  v_add_u32 v15, s35, v15
  v_mfma_f32_16x16x32_bf16 v[148:151], v[216:219], v[192:195], v[148:151]
  v_mfma_f32_16x16x32_bf16 v[152:155], v[220:223], v[192:195], v[152:155]
  s_waitcnt lgkmcnt(0)
  s_barrier
  v_mfma_f32_16x16x32_bf16 v[156:159], v[248:251], v[240:243], v[156:159]
  v_mfma_f32_16x16x32_bf16 v[160:163], v[248:251], v[244:247], v[160:163]
  ds_read_b64_tr_b16 v[248:249], v14 offset:0
  ds_read_b64_tr_b16 v[250:251], v15 offset:0
  v_mfma_f32_16x16x32_bf16 v[28:31], v[224:227], v[164:167], v[28:31]
  ds_read_b128 v[240:243], v12 offset:0
  ds_read_b64_tr_b16 v[208:209], v8 offset:0
  v_mfma_f32_16x16x32_bf16 v[32:35], v[228:231], v[164:167], v[32:35]
  ds_read_b128 v[244:247], v13 offset:2048
  ds_read_b64_tr_b16 v[210:211], v8 offset:2048
  v_mfma_f32_16x16x32_bf16 v[36:39], v[232:235], v[164:167], v[36:39]
  ds_read_b64_tr_b16 v[212:213], v9 offset:0
  v_mfma_f32_16x16x32_bf16 v[40:43], v[236:239], v[164:167], v[40:43]
  ds_read_b64_tr_b16 v[214:215], v9 offset:2048
  ds_read_b128 v[164:167], v6 offset:0
  v_mfma_f32_16x16x32_bf16 v[44:47], v[224:227], v[168:171], v[44:47]
  ds_read_b64_tr_b16 v[216:217], v10 offset:0
  v_mfma_f32_16x16x32_bf16 v[48:51], v[228:231], v[168:171], v[48:51]
  ds_read_b64_tr_b16 v[218:219], v10 offset:2048
  v_mfma_f32_16x16x32_bf16 v[52:55], v[232:235], v[168:171], v[52:55]
  ds_read_b64_tr_b16 v[220:221], v11 offset:0
  v_mfma_f32_16x16x32_bf16 v[56:59], v[236:239], v[168:171], v[56:59]
  ds_read_b64_tr_b16 v[222:223], v11 offset:2048
  ds_read_b128 v[168:171], v7 offset:2048
  v_mfma_f32_16x16x32_bf16 v[60:63], v[224:227], v[172:175], v[60:63]
  ds_read_b128 v[184:187], v7 offset:10240
  v_mfma_f32_16x16x32_bf16 v[64:67], v[228:231], v[172:175], v[64:67]
  ds_read_b128 v[188:191], v6 offset:12288
  v_mfma_f32_16x16x32_bf16 v[68:71], v[232:235], v[172:175], v[68:71]
  ds_read_b128 v[192:195], v7 offset:14336
  v_mfma_f32_16x16x32_bf16 v[72:75], v[236:239], v[172:175], v[72:75]
  ds_read_b128 v[172:175], v6 offset:4096
  v_mfma_f32_16x16x32_bf16 v[76:79], v[224:227], v[176:179], v[76:79]
  v_mfma_f32_16x16x32_bf16 v[80:83], v[228:231], v[176:179], v[80:83]
  v_mfma_f32_16x16x32_bf16 v[84:87], v[232:235], v[176:179], v[84:87]
  v_mfma_f32_16x16x32_bf16 v[88:91], v[236:239], v[176:179], v[88:91]
  ds_read_b128 v[176:179], v7 offset:6144
  v_mfma_f32_16x16x32_bf16 v[92:95], v[224:227], v[180:183], v[92:95]
  v_mfma_f32_16x16x32_bf16 v[96:99], v[228:231], v[180:183], v[96:99]
  v_mfma_f32_16x16x32_bf16 v[100:103], v[232:235], v[180:183], v[100:103]
  v_mfma_f32_16x16x32_bf16 v[104:107], v[236:239], v[180:183], v[104:107]
  ds_read_b128 v[180:183], v6 offset:8192
  v_mfma_f32_16x16x32_bf16 v[108:111], v[224:227], v[196:199], v[108:111]
  s_sub_u32 s34, s34, 1
  v_mfma_f32_16x16x32_bf16 v[112:115], v[228:231], v[196:199], v[112:115]
  s_cmp_lg_u32 s34, 0
  v_mfma_f32_16x16x32_bf16 v[116:119], v[232:235], v[196:199], v[116:119]
  v_mfma_f32_16x16x32_bf16 v[120:123], v[236:239], v[196:199], v[120:123]
  v_mfma_f32_16x16x32_bf16 v[124:127], v[224:227], v[200:203], v[124:127]
  v_mfma_f32_16x16x32_bf16 v[128:131], v[228:231], v[200:203], v[128:131]
  v_mfma_f32_16x16x32_bf16 v[132:135], v[232:235], v[200:203], v[132:135]
  v_mfma_f32_16x16x32_bf16 v[136:139], v[236:239], v[200:203], v[136:139]
  v_mfma_f32_16x16x32_bf16 v[140:143], v[224:227], v[204:207], v[140:143]
  v_mfma_f32_16x16x32_bf16 v[144:147], v[228:231], v[204:207], v[144:147]
  v_mfma_f32_16x16x32_bf16 v[148:151], v[232:235], v[204:207], v[148:151]
  v_mfma_f32_16x16x32_bf16 v[152:155], v[236:239], v[204:207], v[152:155]
  s_cbranch_scc1 L_proj_kernel_ak_loop
  s_cmp_lg_u32 s3, 0
  s_cbranch_scc1 L_proj_kernel_ak_notag
  global_load_dwordx2 v[26:27], v24, s[98:99] sc0 sc1
L_proj_kernel_ak_notag:
  s_waitcnt lgkmcnt(0)
  v_mfma_f32_16x16x32_bf16 v[156:159], v[248:251], v[240:243], v[156:159]
  v_mfma_f32_16x16x32_bf16 v[160:163], v[248:251], v[244:247], v[160:163]
  ds_read_b64_tr_b16 v[248:249], v14 offset:1024
  ds_read_b64_tr_b16 v[250:251], v15 offset:1024
  v_mfma_f32_16x16x32_bf16 v[28:31], v[208:211], v[164:167], v[28:31]
  ds_read_b128 v[240:243], v13 offset:0
  ds_read_b64_tr_b16 v[224:225], v8 offset:16384
  v_mfma_f32_16x16x32_bf16 v[32:35], v[212:215], v[164:167], v[32:35]
  ds_read_b128 v[244:247], v12 offset:2048
  ds_read_b64_tr_b16 v[226:227], v8 offset:18432
  v_mfma_f32_16x16x32_bf16 v[36:39], v[216:219], v[164:167], v[36:39]
  ds_read_b64_tr_b16 v[228:229], v9 offset:16384
  v_mfma_f32_16x16x32_bf16 v[40:43], v[220:223], v[164:167], v[40:43]
  ds_read_b64_tr_b16 v[230:231], v9 offset:18432
  ds_read_b128 v[164:167], v7 offset:0
  v_mfma_f32_16x16x32_bf16 v[44:47], v[208:211], v[168:171], v[44:47]
  ds_read_b64_tr_b16 v[232:233], v10 offset:16384
  v_mfma_f32_16x16x32_bf16 v[48:51], v[212:215], v[168:171], v[48:51]
  ds_read_b64_tr_b16 v[234:235], v10 offset:18432
  v_mfma_f32_16x16x32_bf16 v[52:55], v[216:219], v[168:171], v[52:55]
  ds_read_b64_tr_b16 v[236:237], v11 offset:16384
  v_mfma_f32_16x16x32_bf16 v[56:59], v[220:223], v[168:171], v[56:59]
  ds_read_b64_tr_b16 v[238:239], v11 offset:18432
  ds_read_b128 v[168:171], v6 offset:2048
  v_mfma_f32_16x16x32_bf16 v[60:63], v[208:211], v[172:175], v[60:63]
  ds_read_b128 v[196:199], v6 offset:10240
  v_mfma_f32_16x16x32_bf16 v[64:67], v[212:215], v[172:175], v[64:67]
  ds_read_b128 v[200:203], v7 offset:12288
  v_mfma_f32_16x16x32_bf16 v[68:71], v[216:219], v[172:175], v[68:71]
  ds_read_b128 v[204:207], v6 offset:14336
  v_mfma_f32_16x16x32_bf16 v[72:75], v[220:223], v[172:175], v[72:75]
  ds_read_b128 v[172:175], v7 offset:4096
  v_mfma_f32_16x16x32_bf16 v[76:79], v[208:211], v[176:179], v[76:79]
  v_mfma_f32_16x16x32_bf16 v[80:83], v[212:215], v[176:179], v[80:83]
  v_mfma_f32_16x16x32_bf16 v[84:87], v[216:219], v[176:179], v[84:87]
  v_mfma_f32_16x16x32_bf16 v[88:91], v[220:223], v[176:179], v[88:91]
  ds_read_b128 v[176:179], v6 offset:6144
  s_waitcnt lgkmcnt(5)
  v_mfma_f32_16x16x32_bf16 v[156:159], v[248:251], v[240:243], v[156:159]
  v_mfma_f32_16x16x32_bf16 v[160:163], v[248:251], v[244:247], v[160:163]
  v_mfma_f32_16x16x32_bf16 v[28:31], v[224:227], v[164:167], v[28:31]
  v_mfma_f32_16x16x32_bf16 v[32:35], v[228:231], v[164:167], v[32:35]
  v_mfma_f32_16x16x32_bf16 v[36:39], v[232:235], v[164:167], v[36:39]
  v_mfma_f32_16x16x32_bf16 v[40:43], v[236:239], v[164:167], v[40:43]
  v_mfma_f32_16x16x32_bf16 v[44:47], v[224:227], v[168:171], v[44:47]
  v_mfma_f32_16x16x32_bf16 v[48:51], v[228:231], v[168:171], v[48:51]
  v_mfma_f32_16x16x32_bf16 v[52:55], v[232:235], v[168:171], v[52:55]
  v_mfma_f32_16x16x32_bf16 v[56:59], v[236:239], v[168:171], v[56:59]
  s_waitcnt lgkmcnt(1)
  v_mfma_f32_16x16x32_bf16 v[60:63], v[224:227], v[172:175], v[60:63]
  v_mfma_f32_16x16x32_bf16 v[64:67], v[228:231], v[172:175], v[64:67]
  v_mfma_f32_16x16x32_bf16 v[68:71], v[232:235], v[172:175], v[68:71]
  v_mfma_f32_16x16x32_bf16 v[72:75], v[236:239], v[172:175], v[72:75]
  s_waitcnt lgkmcnt(0)
  v_mfma_f32_16x16x32_bf16 v[76:79], v[224:227], v[176:179], v[76:79]
  v_mfma_f32_16x16x32_bf16 v[80:83], v[228:231], v[176:179], v[80:83]
  v_mfma_f32_16x16x32_bf16 v[84:87], v[232:235], v[176:179], v[84:87]
  v_mfma_f32_16x16x32_bf16 v[88:91], v[236:239], v[176:179], v[88:91]
  v_mfma_f32_16x16x32_bf16 v[92:95], v[208:211], v[180:183], v[92:95]
  s_add_u32 s30, s43, 0
  v_pk_mul_f32 v[28:29], v[28:29], s[56:57]
  v_pk_mul_f32 v[30:31], v[30:31], s[56:57]
  v_mfma_f32_16x16x32_bf16 v[96:99], v[212:215], v[180:183], v[96:99]
  v_pk_mul_f32 v[32:33], v[32:33], s[56:57]
  v_pk_mul_f32 v[34:35], v[34:35], s[56:57]
  v_mfma_f32_16x16x32_bf16 v[100:103], v[216:219], v[180:183], v[100:103]
  v_cvt_pk_bf16_f32 v164, v28, v29
  v_cvt_pk_bf16_f32 v165, v30, v31
  v_cvt_pk_bf16_f32 v166, v32, v33
  v_mfma_f32_16x16x32_bf16 v[104:107], v[220:223], v[180:183], v[104:107]
  ds_read_b128 v[180:183], v7 offset:8192
  v_cvt_pk_bf16_f32 v167, v34, v35
  buffer_store_dwordx4 v[164:167], v16, s[20:23], s30 offen offset:0 sc0 sc1
  v_mfma_f32_16x16x32_bf16 v[108:111], v[208:211], v[184:187], v[108:111]
  v_pk_mul_f32 v[44:45], v[44:45], s[56:57]
  v_pk_mul_f32 v[46:47], v[46:47], s[56:57]
  v_mfma_f32_16x16x32_bf16 v[112:115], v[212:215], v[184:187], v[112:115]
  v_pk_mul_f32 v[48:49], v[48:49], s[56:57]
  v_pk_mul_f32 v[50:51], v[50:51], s[56:57]
  v_cvt_pk_bf16_f32 v168, v44, v45
  v_mfma_f32_16x16x32_bf16 v[116:119], v[216:219], v[184:187], v[116:119]
  v_cvt_pk_bf16_f32 v169, v46, v47
  v_cvt_pk_bf16_f32 v170, v48, v49
  v_mfma_f32_16x16x32_bf16 v[120:123], v[220:223], v[184:187], v[120:123]
  v_cvt_pk_bf16_f32 v171, v50, v51
  buffer_store_dwordx4 v[168:171], v16, s[20:23], s30 offen offset:256 sc0 sc1
  v_mfma_f32_16x16x32_bf16 v[124:127], v[208:211], v[188:191], v[124:127]
  s_add_u32 s30, s43, 131072
  v_pk_mul_f32 v[36:37], v[36:37], s[56:57]
  v_pk_mul_f32 v[38:39], v[38:39], s[56:57]
  v_mfma_f32_16x16x32_bf16 v[128:131], v[212:215], v[188:191], v[128:131]
  v_pk_mul_f32 v[40:41], v[40:41], s[56:57]
  v_pk_mul_f32 v[42:43], v[42:43], s[56:57]
  v_mfma_f32_16x16x32_bf16 v[132:135], v[216:219], v[188:191], v[132:135]
  v_cvt_pk_bf16_f32 v172, v36, v37
  v_cvt_pk_bf16_f32 v173, v38, v39
  v_cvt_pk_bf16_f32 v174, v40, v41
  v_mfma_f32_16x16x32_bf16 v[136:139], v[220:223], v[188:191], v[136:139]
  v_cvt_pk_bf16_f32 v175, v42, v43
  buffer_store_dwordx4 v[172:175], v16, s[20:23], s30 offen offset:0 sc0 sc1
  v_mfma_f32_16x16x32_bf16 v[140:143], v[208:211], v[192:195], v[140:143]
  v_pk_mul_f32 v[52:53], v[52:53], s[56:57]
  v_pk_mul_f32 v[54:55], v[54:55], s[56:57]
  v_mfma_f32_16x16x32_bf16 v[144:147], v[212:215], v[192:195], v[144:147]
  v_pk_mul_f32 v[56:57], v[56:57], s[56:57]
  v_pk_mul_f32 v[58:59], v[58:59], s[56:57]
  v_cvt_pk_bf16_f32 v176, v52, v53
  v_mfma_f32_16x16x32_bf16 v[148:151], v[216:219], v[192:195], v[148:151]
  v_cvt_pk_bf16_f32 v177, v54, v55
  v_cvt_pk_bf16_f32 v178, v56, v57
  v_mfma_f32_16x16x32_bf16 v[152:155], v[220:223], v[192:195], v[152:155]
  v_cvt_pk_bf16_f32 v179, v58, v59
  buffer_store_dwordx4 v[176:179], v16, s[20:23], s30 offen offset:256 sc0 sc1
  s_waitcnt lgkmcnt(0)
  v_mfma_f32_16x16x32_bf16 v[92:95], v[224:227], v[180:183], v[92:95]
  s_add_u32 s30, s43, 2048
  v_pk_mul_f32 v[60:61], v[60:61], s[56:57]
  v_pk_mul_f32 v[62:63], v[62:63], s[56:57]
  v_mfma_f32_16x16x32_bf16 v[96:99], v[228:231], v[180:183], v[96:99]
  v_pk_mul_f32 v[64:65], v[64:65], s[56:57]
  v_pk_mul_f32 v[66:67], v[66:67], s[56:57]
  v_mfma_f32_16x16x32_bf16 v[100:103], v[232:235], v[180:183], v[100:103]
  v_cvt_pk_bf16_f32 v164, v60, v61
  v_cvt_pk_bf16_f32 v165, v62, v63
  v_cvt_pk_bf16_f32 v166, v64, v65
  v_mfma_f32_16x16x32_bf16 v[104:107], v[236:239], v[180:183], v[104:107]
  v_cvt_pk_bf16_f32 v167, v66, v67
  buffer_store_dwordx4 v[164:167], v16, s[20:23], s30 offen offset:0 sc0 sc1
  v_mfma_f32_16x16x32_bf16 v[108:111], v[224:227], v[196:199], v[108:111]
  v_pk_mul_f32 v[76:77], v[76:77], s[56:57]
  v_pk_mul_f32 v[78:79], v[78:79], s[56:57]
  v_mfma_f32_16x16x32_bf16 v[112:115], v[228:231], v[196:199], v[112:115]
  v_pk_mul_f32 v[80:81], v[80:81], s[56:57]
  v_pk_mul_f32 v[82:83], v[82:83], s[56:57]
  v_cvt_pk_bf16_f32 v168, v76, v77
  v_mfma_f32_16x16x32_bf16 v[116:119], v[232:235], v[196:199], v[116:119]
  v_cvt_pk_bf16_f32 v169, v78, v79
  v_cvt_pk_bf16_f32 v170, v80, v81
  v_mfma_f32_16x16x32_bf16 v[120:123], v[236:239], v[196:199], v[120:123]
  v_cvt_pk_bf16_f32 v171, v82, v83
  buffer_store_dwordx4 v[168:171], v16, s[20:23], s30 offen offset:256 sc0 sc1
  v_mfma_f32_16x16x32_bf16 v[124:127], v[224:227], v[200:203], v[124:127]
  s_add_u32 s30, s43, 133120
  v_pk_mul_f32 v[68:69], v[68:69], s[56:57]
  v_pk_mul_f32 v[70:71], v[70:71], s[56:57]
  v_mfma_f32_16x16x32_bf16 v[128:131], v[228:231], v[200:203], v[128:131]
  v_pk_mul_f32 v[72:73], v[72:73], s[56:57]
  v_pk_mul_f32 v[74:75], v[74:75], s[56:57]
  v_mfma_f32_16x16x32_bf16 v[132:135], v[232:235], v[200:203], v[132:135]
  v_cvt_pk_bf16_f32 v172, v68, v69
  v_cvt_pk_bf16_f32 v173, v70, v71
  v_cvt_pk_bf16_f32 v174, v72, v73
  v_mfma_f32_16x16x32_bf16 v[136:139], v[236:239], v[200:203], v[136:139]
  v_cvt_pk_bf16_f32 v175, v74, v75
  buffer_store_dwordx4 v[172:175], v16, s[20:23], s30 offen offset:0 sc0 sc1
  v_mfma_f32_16x16x32_bf16 v[140:143], v[224:227], v[204:207], v[140:143]
  v_pk_mul_f32 v[84:85], v[84:85], s[56:57]
  v_pk_mul_f32 v[86:87], v[86:87], s[56:57]
  v_mfma_f32_16x16x32_bf16 v[144:147], v[228:231], v[204:207], v[144:147]
  v_pk_mul_f32 v[88:89], v[88:89], s[56:57]
  v_pk_mul_f32 v[90:91], v[90:91], s[56:57]
  v_cvt_pk_bf16_f32 v176, v84, v85
  v_mfma_f32_16x16x32_bf16 v[148:151], v[232:235], v[204:207], v[148:151]
  v_cvt_pk_bf16_f32 v177, v86, v87
  v_cvt_pk_bf16_f32 v178, v88, v89
  v_mfma_f32_16x16x32_bf16 v[152:155], v[236:239], v[204:207], v[152:155]
  v_cvt_pk_bf16_f32 v179, v90, v91
  buffer_store_dwordx4 v[176:179], v16, s[20:23], s30 offen offset:256 sc0 sc1
  s_nop 7
  s_add_u32 s30, s43, 4096
  v_pk_mul_f32 v[92:93], v[92:93], s[56:57]
  v_pk_mul_f32 v[94:95], v[94:95], s[56:57]
  v_pk_mul_f32 v[96:97], v[96:97], s[56:57]
  v_pk_mul_f32 v[98:99], v[98:99], s[56:57]
  v_cvt_pk_bf16_f32 v164, v92, v93
  v_cvt_pk_bf16_f32 v165, v94, v95
  v_cvt_pk_bf16_f32 v166, v96, v97
  v_cvt_pk_bf16_f32 v167, v98, v99
  buffer_store_dwordx4 v[164:167], v16, s[20:23], s30 offen offset:0 sc0 sc1
  v_pk_mul_f32 v[108:109], v[108:109], s[56:57]
  v_pk_mul_f32 v[110:111], v[110:111], s[56:57]
  v_pk_mul_f32 v[112:113], v[112:113], s[56:57]
  v_pk_mul_f32 v[114:115], v[114:115], s[56:57]
  v_cvt_pk_bf16_f32 v168, v108, v109
  v_cvt_pk_bf16_f32 v169, v110, v111
  v_cvt_pk_bf16_f32 v170, v112, v113
  v_cvt_pk_bf16_f32 v171, v114, v115
  buffer_store_dwordx4 v[168:171], v16, s[20:23], s30 offen offset:256 sc0 sc1
  s_add_u32 s30, s43, 135168
  v_pk_mul_f32 v[100:101], v[100:101], s[56:57]
  v_pk_mul_f32 v[102:103], v[102:103], s[56:57]
  v_pk_mul_f32 v[104:105], v[104:105], s[56:57]
  v_pk_mul_f32 v[106:107], v[106:107], s[56:57]
  v_cvt_pk_bf16_f32 v172, v100, v101
  v_cvt_pk_bf16_f32 v173, v102, v103
  v_cvt_pk_bf16_f32 v174, v104, v105
  v_cvt_pk_bf16_f32 v175, v106, v107
  buffer_store_dwordx4 v[172:175], v16, s[20:23], s30 offen offset:0 sc0 sc1
  v_pk_mul_f32 v[116:117], v[116:117], s[56:57]
  v_pk_mul_f32 v[118:119], v[118:119], s[56:57]
  v_pk_mul_f32 v[120:121], v[120:121], s[56:57]
  v_pk_mul_f32 v[122:123], v[122:123], s[56:57]
  v_cvt_pk_bf16_f32 v176, v116, v117
  v_cvt_pk_bf16_f32 v177, v118, v119
  v_cvt_pk_bf16_f32 v178, v120, v121
  v_cvt_pk_bf16_f32 v179, v122, v123
  buffer_store_dwordx4 v[176:179], v16, s[20:23], s30 offen offset:256 sc0 sc1
  s_add_u32 s30, s43, 6144
  v_pk_mul_f32 v[124:125], v[124:125], s[56:57]
  v_pk_mul_f32 v[126:127], v[126:127], s[56:57]
  v_pk_mul_f32 v[128:129], v[128:129], s[56:57]
  v_pk_mul_f32 v[130:131], v[130:131], s[56:57]
  v_cvt_pk_bf16_f32 v164, v124, v125
  v_cvt_pk_bf16_f32 v165, v126, v127
  v_cvt_pk_bf16_f32 v166, v128, v129
  v_cvt_pk_bf16_f32 v167, v130, v131
  buffer_store_dwordx4 v[164:167], v16, s[20:23], s30 offen offset:0 sc0 sc1
  v_pk_mul_f32 v[140:141], v[140:141], s[56:57]
  v_pk_mul_f32 v[142:143], v[142:143], s[56:57]
  v_pk_mul_f32 v[144:145], v[144:145], s[56:57]
  v_pk_mul_f32 v[146:147], v[146:147], s[56:57]
  v_cvt_pk_bf16_f32 v168, v140, v141
  v_cvt_pk_bf16_f32 v169, v142, v143
  v_cvt_pk_bf16_f32 v170, v144, v145
  v_cvt_pk_bf16_f32 v171, v146, v147
  buffer_store_dwordx4 v[168:171], v16, s[20:23], s30 offen offset:256 sc0 sc1
  s_add_u32 s30, s43, 137216
  v_pk_mul_f32 v[132:133], v[132:133], s[56:57]
  v_pk_mul_f32 v[134:135], v[134:135], s[56:57]
  v_pk_mul_f32 v[136:137], v[136:137], s[56:57]
  v_pk_mul_f32 v[138:139], v[138:139], s[56:57]
  v_cvt_pk_bf16_f32 v172, v132, v133
  v_cvt_pk_bf16_f32 v173, v134, v135
  v_cvt_pk_bf16_f32 v174, v136, v137
  v_cvt_pk_bf16_f32 v175, v138, v139
  buffer_store_dwordx4 v[172:175], v16, s[20:23], s30 offen offset:0 sc0 sc1
  v_pk_mul_f32 v[148:149], v[148:149], s[56:57]
  v_pk_mul_f32 v[150:151], v[150:151], s[56:57]
  v_pk_mul_f32 v[152:153], v[152:153], s[56:57]
  v_pk_mul_f32 v[154:155], v[154:155], s[56:57]
  v_cvt_pk_bf16_f32 v176, v148, v149
  v_cvt_pk_bf16_f32 v177, v150, v151
  v_cvt_pk_bf16_f32 v178, v152, v153
  v_cvt_pk_bf16_f32 v179, v154, v155
  buffer_store_dwordx4 v[176:179], v16, s[20:23], s30 offen offset:256 sc0 sc1
  v_cvt_pk_bf16_f32 v208, v156, v157
  v_cvt_pk_bf16_f32 v209, v158, v159
  v_cvt_pk_bf16_f32 v210, v160, v161
  v_cvt_pk_bf16_f32 v211, v162, v163
  v_and_b32 v1, 0x200, v16
  v_lshrrev_b32 v2, 2, v16
  v_and_b32 v2, 0x100, v2
  v_permlane32_swap_b32 v208, v210
  v_permlane32_swap_b32 v209, v211
  v_and_b32 v3, 0xf0, v16
  v_or3_b32 v1, v1, v2, v3
  buffer_store_dwordx4 v[208:211], v1, s[20:23], s44 offen sc0 sc1
  s_branch L_proj_kernel_done
L_proj_kernel_cBQ:
  s_lshl_b32 s43, s30, 11
  s_add_u32 s43, s43, 4194304
  s_branch L_proj_kernel_cBQK
L_proj_kernel_cBK:
  s_lshl_b32 s43, s30, 11
  s_add_u32 s43, s43, 8388608
L_proj_kernel_cBQK:
  ds_read_b64_tr_b16 v[208:209], v8 offset:0
  ds_read_b64_tr_b16 v[210:211], v8 offset:2048
  ds_read_b64_tr_b16 v[212:213], v9 offset:0
  ds_read_b64_tr_b16 v[214:215], v9 offset:2048
  ds_read_b64_tr_b16 v[216:217], v10 offset:0
  ds_read_b64_tr_b16 v[218:219], v10 offset:2048
  ds_read_b64_tr_b16 v[220:221], v11 offset:0
  ds_read_b64_tr_b16 v[222:223], v11 offset:2048
  s_waitcnt lgkmcnt(4)
  ds_read_b128 v[164:167], v6 offset:0
  ds_read_b128 v[168:171], v7 offset:2048
  ds_read_b128 v[172:175], v6 offset:4096
  ds_read_b128 v[176:179], v7 offset:6144
  ds_read_b128 v[180:183], v6 offset:8192
  ds_read_b128 v[184:187], v7 offset:10240
  ds_read_b128 v[188:191], v6 offset:12288
  ds_read_b128 v[192:195], v7 offset:14336
  s_mov_b32 s34, 15
  .p2align 6
L_proj_kernel_bqk_loop:
  s_waitcnt lgkmcnt(0)
  v_mfma_f32_16x16x32_bf16 v[28:31], v[208:211], v[164:167], v[28:31]
  ds_read_b64_tr_b16 v[224:225], v8 offset:16384
  v_mfma_f32_16x16x32_bf16 v[32:35], v[212:215], v[164:167], v[32:35]
  ds_read_b64_tr_b16 v[226:227], v8 offset:18432
  v_mfma_f32_16x16x32_bf16 v[36:39], v[216:219], v[164:167], v[36:39]
  ds_read_b64_tr_b16 v[228:229], v9 offset:16384
  v_mfma_f32_16x16x32_bf16 v[40:43], v[220:223], v[164:167], v[40:43]
  ds_read_b64_tr_b16 v[230:231], v9 offset:18432
  ds_read_b128 v[164:167], v7 offset:0
  v_mfma_f32_16x16x32_bf16 v[44:47], v[208:211], v[168:171], v[44:47]
  ds_read_b64_tr_b16 v[232:233], v10 offset:16384
  v_mfma_f32_16x16x32_bf16 v[48:51], v[212:215], v[168:171], v[48:51]
  ds_read_b64_tr_b16 v[234:235], v10 offset:18432
  v_mfma_f32_16x16x32_bf16 v[52:55], v[216:219], v[168:171], v[52:55]
  ds_read_b64_tr_b16 v[236:237], v11 offset:16384
  v_mfma_f32_16x16x32_bf16 v[56:59], v[220:223], v[168:171], v[56:59]
  ds_read_b64_tr_b16 v[238:239], v11 offset:18432
  ds_read_b128 v[168:171], v6 offset:2048
  v_mfma_f32_16x16x32_bf16 v[60:63], v[208:211], v[172:175], v[60:63]
  ds_read_b128 v[196:199], v6 offset:10240
  v_mfma_f32_16x16x32_bf16 v[64:67], v[212:215], v[172:175], v[64:67]
  ds_read_b128 v[200:203], v7 offset:12288
  v_mfma_f32_16x16x32_bf16 v[68:71], v[216:219], v[172:175], v[68:71]
  ds_read_b128 v[204:207], v6 offset:14336
  v_mfma_f32_16x16x32_bf16 v[72:75], v[220:223], v[172:175], v[72:75]
  ds_read_b128 v[172:175], v7 offset:4096
  v_mfma_f32_16x16x32_bf16 v[76:79], v[208:211], v[176:179], v[76:79]
  s_add_u32 s36, s36, 1
  v_mfma_f32_16x16x32_bf16 v[80:83], v[212:215], v[176:179], v[80:83]
  s_cmp_eq_u32 s36, 3
  v_mfma_f32_16x16x32_bf16 v[84:87], v[216:219], v[176:179], v[84:87]
  s_cselect_b32 s35, s45, 51200
  v_mfma_f32_16x16x32_bf16 v[88:91], v[220:223], v[176:179], v[88:91]
  ds_read_b128 v[176:179], v6 offset:6144
  v_mfma_f32_16x16x32_bf16 v[92:95], v[208:211], v[180:183], v[92:95]
  s_cselect_b32 s36, 0, s36
  v_mfma_f32_16x16x32_bf16 v[96:99], v[212:215], v[180:183], v[96:99]
  v_mfma_f32_16x16x32_bf16 v[100:103], v[216:219], v[180:183], v[100:103]
  v_mfma_f32_16x16x32_bf16 v[104:107], v[220:223], v[180:183], v[104:107]
  ds_read_b128 v[180:183], v7 offset:8192
  v_mfma_f32_16x16x32_bf16 v[108:111], v[208:211], v[184:187], v[108:111]
  v_add_u32 v6, s35, v6
  v_mfma_f32_16x16x32_bf16 v[112:115], v[212:215], v[184:187], v[112:115]
  v_add_u32 v7, s35, v7
  v_mfma_f32_16x16x32_bf16 v[116:119], v[216:219], v[184:187], v[116:119]
  v_add_u32 v8, s35, v8
  v_mfma_f32_16x16x32_bf16 v[120:123], v[220:223], v[184:187], v[120:123]
  v_add_u32 v9, s35, v9
  v_mfma_f32_16x16x32_bf16 v[124:127], v[208:211], v[188:191], v[124:127]
  v_add_u32 v10, s35, v10
  v_mfma_f32_16x16x32_bf16 v[128:131], v[212:215], v[188:191], v[128:131]
  v_add_u32 v11, s35, v11
  v_mfma_f32_16x16x32_bf16 v[132:135], v[216:219], v[188:191], v[132:135]
  v_mfma_f32_16x16x32_bf16 v[136:139], v[220:223], v[188:191], v[136:139]
  v_mfma_f32_16x16x32_bf16 v[140:143], v[208:211], v[192:195], v[140:143]
  v_mfma_f32_16x16x32_bf16 v[144:147], v[212:215], v[192:195], v[144:147]
  v_mfma_f32_16x16x32_bf16 v[148:151], v[216:219], v[192:195], v[148:151]
  v_mfma_f32_16x16x32_bf16 v[152:155], v[220:223], v[192:195], v[152:155]
  s_waitcnt lgkmcnt(0)
  s_barrier
  v_mfma_f32_16x16x32_bf16 v[28:31], v[224:227], v[164:167], v[28:31]
  ds_read_b64_tr_b16 v[208:209], v8 offset:0
  v_mfma_f32_16x16x32_bf16 v[32:35], v[228:231], v[164:167], v[32:35]
  ds_read_b64_tr_b16 v[210:211], v8 offset:2048
  v_mfma_f32_16x16x32_bf16 v[36:39], v[232:235], v[164:167], v[36:39]
  ds_read_b64_tr_b16 v[212:213], v9 offset:0
  v_mfma_f32_16x16x32_bf16 v[40:43], v[236:239], v[164:167], v[40:43]
  ds_read_b64_tr_b16 v[214:215], v9 offset:2048
  ds_read_b128 v[164:167], v6 offset:0
  v_mfma_f32_16x16x32_bf16 v[44:47], v[224:227], v[168:171], v[44:47]
  ds_read_b64_tr_b16 v[216:217], v10 offset:0
  v_mfma_f32_16x16x32_bf16 v[48:51], v[228:231], v[168:171], v[48:51]
  ds_read_b64_tr_b16 v[218:219], v10 offset:2048
  v_mfma_f32_16x16x32_bf16 v[52:55], v[232:235], v[168:171], v[52:55]
  ds_read_b64_tr_b16 v[220:221], v11 offset:0
  v_mfma_f32_16x16x32_bf16 v[56:59], v[236:239], v[168:171], v[56:59]
  ds_read_b64_tr_b16 v[222:223], v11 offset:2048
  ds_read_b128 v[168:171], v7 offset:2048
  v_mfma_f32_16x16x32_bf16 v[60:63], v[224:227], v[172:175], v[60:63]
  ds_read_b128 v[184:187], v7 offset:10240
  v_mfma_f32_16x16x32_bf16 v[64:67], v[228:231], v[172:175], v[64:67]
  ds_read_b128 v[188:191], v6 offset:12288
  v_mfma_f32_16x16x32_bf16 v[68:71], v[232:235], v[172:175], v[68:71]
  ds_read_b128 v[192:195], v7 offset:14336
  v_mfma_f32_16x16x32_bf16 v[72:75], v[236:239], v[172:175], v[72:75]
  ds_read_b128 v[172:175], v6 offset:4096
  v_mfma_f32_16x16x32_bf16 v[76:79], v[224:227], v[176:179], v[76:79]
  v_mfma_f32_16x16x32_bf16 v[80:83], v[228:231], v[176:179], v[80:83]
  v_mfma_f32_16x16x32_bf16 v[84:87], v[232:235], v[176:179], v[84:87]
  v_mfma_f32_16x16x32_bf16 v[88:91], v[236:239], v[176:179], v[88:91]
  ds_read_b128 v[176:179], v7 offset:6144
  v_mfma_f32_16x16x32_bf16 v[92:95], v[224:227], v[180:183], v[92:95]
  v_mfma_f32_16x16x32_bf16 v[96:99], v[228:231], v[180:183], v[96:99]
  v_mfma_f32_16x16x32_bf16 v[100:103], v[232:235], v[180:183], v[100:103]
  v_mfma_f32_16x16x32_bf16 v[104:107], v[236:239], v[180:183], v[104:107]
  ds_read_b128 v[180:183], v6 offset:8192
  v_mfma_f32_16x16x32_bf16 v[108:111], v[224:227], v[196:199], v[108:111]
  s_sub_u32 s34, s34, 1
  v_mfma_f32_16x16x32_bf16 v[112:115], v[228:231], v[196:199], v[112:115]
  s_cmp_lg_u32 s34, 0
  v_mfma_f32_16x16x32_bf16 v[116:119], v[232:235], v[196:199], v[116:119]
  v_mfma_f32_16x16x32_bf16 v[120:123], v[236:239], v[196:199], v[120:123]
  v_mfma_f32_16x16x32_bf16 v[124:127], v[224:227], v[200:203], v[124:127]
  v_mfma_f32_16x16x32_bf16 v[128:131], v[228:231], v[200:203], v[128:131]
  v_mfma_f32_16x16x32_bf16 v[132:135], v[232:235], v[200:203], v[132:135]
  v_mfma_f32_16x16x32_bf16 v[136:139], v[236:239], v[200:203], v[136:139]
  v_mfma_f32_16x16x32_bf16 v[140:143], v[224:227], v[204:207], v[140:143]
  v_mfma_f32_16x16x32_bf16 v[144:147], v[228:231], v[204:207], v[144:147]
  v_mfma_f32_16x16x32_bf16 v[148:151], v[232:235], v[204:207], v[148:151]
  v_mfma_f32_16x16x32_bf16 v[152:155], v[236:239], v[204:207], v[152:155]
  s_cbranch_scc1 L_proj_kernel_bqk_loop
  s_cmp_lg_u32 s3, 0
  s_cbranch_scc1 L_proj_kernel_bqk_notag
  global_load_dwordx2 v[26:27], v24, s[98:99] sc0 sc1
L_proj_kernel_bqk_notag:
  s_waitcnt lgkmcnt(0)
  v_mfma_f32_16x16x32_bf16 v[28:31], v[208:211], v[164:167], v[28:31]
  ds_read_b64_tr_b16 v[224:225], v8 offset:16384
  v_mfma_f32_16x16x32_bf16 v[32:35], v[212:215], v[164:167], v[32:35]
  ds_read_b64_tr_b16 v[226:227], v8 offset:18432
  v_mfma_f32_16x16x32_bf16 v[36:39], v[216:219], v[164:167], v[36:39]
  ds_read_b64_tr_b16 v[228:229], v9 offset:16384
  v_mfma_f32_16x16x32_bf16 v[40:43], v[220:223], v[164:167], v[40:43]
  ds_read_b64_tr_b16 v[230:231], v9 offset:18432
  ds_read_b128 v[164:167], v7 offset:0
  v_mfma_f32_16x16x32_bf16 v[44:47], v[208:211], v[168:171], v[44:47]
  ds_read_b64_tr_b16 v[232:233], v10 offset:16384
  v_mfma_f32_16x16x32_bf16 v[48:51], v[212:215], v[168:171], v[48:51]
  ds_read_b64_tr_b16 v[234:235], v10 offset:18432
  v_mfma_f32_16x16x32_bf16 v[52:55], v[216:219], v[168:171], v[52:55]
  ds_read_b64_tr_b16 v[236:237], v11 offset:16384
  v_mfma_f32_16x16x32_bf16 v[56:59], v[220:223], v[168:171], v[56:59]
  ds_read_b64_tr_b16 v[238:239], v11 offset:18432
  ds_read_b128 v[168:171], v6 offset:2048
  v_mfma_f32_16x16x32_bf16 v[60:63], v[208:211], v[172:175], v[60:63]
  ds_read_b128 v[196:199], v6 offset:10240
  v_mfma_f32_16x16x32_bf16 v[64:67], v[212:215], v[172:175], v[64:67]
  ds_read_b128 v[200:203], v7 offset:12288
  v_mfma_f32_16x16x32_bf16 v[68:71], v[216:219], v[172:175], v[68:71]
  ds_read_b128 v[204:207], v6 offset:14336
  v_mfma_f32_16x16x32_bf16 v[72:75], v[220:223], v[172:175], v[72:75]
  ds_read_b128 v[172:175], v7 offset:4096
  v_mfma_f32_16x16x32_bf16 v[76:79], v[208:211], v[176:179], v[76:79]
  v_mfma_f32_16x16x32_bf16 v[80:83], v[212:215], v[176:179], v[80:83]
  v_mfma_f32_16x16x32_bf16 v[84:87], v[216:219], v[176:179], v[84:87]
  v_mfma_f32_16x16x32_bf16 v[88:91], v[220:223], v[176:179], v[88:91]
  ds_read_b128 v[176:179], v6 offset:6144
  v_mfma_f32_16x16x32_bf16 v[92:95], v[208:211], v[180:183], v[92:95]
  v_mfma_f32_16x16x32_bf16 v[96:99], v[212:215], v[180:183], v[96:99]
  v_mfma_f32_16x16x32_bf16 v[100:103], v[216:219], v[180:183], v[100:103]
  v_mfma_f32_16x16x32_bf16 v[104:107], v[220:223], v[180:183], v[104:107]
  ds_read_b128 v[180:183], v7 offset:8192
  v_mfma_f32_16x16x32_bf16 v[108:111], v[208:211], v[184:187], v[108:111]
  v_mfma_f32_16x16x32_bf16 v[112:115], v[212:215], v[184:187], v[112:115]
  v_mfma_f32_16x16x32_bf16 v[116:119], v[216:219], v[184:187], v[116:119]
  v_mfma_f32_16x16x32_bf16 v[120:123], v[220:223], v[184:187], v[120:123]
  v_mfma_f32_16x16x32_bf16 v[124:127], v[208:211], v[188:191], v[124:127]
  v_mfma_f32_16x16x32_bf16 v[128:131], v[212:215], v[188:191], v[128:131]
  v_mfma_f32_16x16x32_bf16 v[132:135], v[216:219], v[188:191], v[132:135]
  v_mfma_f32_16x16x32_bf16 v[136:139], v[220:223], v[188:191], v[136:139]
  v_mfma_f32_16x16x32_bf16 v[140:143], v[208:211], v[192:195], v[140:143]
  v_mfma_f32_16x16x32_bf16 v[144:147], v[212:215], v[192:195], v[144:147]
  v_mfma_f32_16x16x32_bf16 v[148:151], v[216:219], v[192:195], v[148:151]
  v_mfma_f32_16x16x32_bf16 v[152:155], v[220:223], v[192:195], v[152:155]
  s_waitcnt lgkmcnt(0)
  v_mfma_f32_16x16x32_bf16 v[28:31], v[224:227], v[164:167], v[28:31]
  v_mfma_f32_16x16x32_bf16 v[32:35], v[228:231], v[164:167], v[32:35]
  v_mfma_f32_16x16x32_bf16 v[36:39], v[232:235], v[164:167], v[36:39]
  v_mfma_f32_16x16x32_bf16 v[40:43], v[236:239], v[164:167], v[40:43]
  v_mfma_f32_16x16x32_bf16 v[44:47], v[224:227], v[168:171], v[44:47]
  v_mfma_f32_16x16x32_bf16 v[48:51], v[228:231], v[168:171], v[48:51]
  v_mfma_f32_16x16x32_bf16 v[52:55], v[232:235], v[168:171], v[52:55]
  v_mfma_f32_16x16x32_bf16 v[56:59], v[236:239], v[168:171], v[56:59]
  v_mfma_f32_16x16x32_bf16 v[60:63], v[224:227], v[172:175], v[60:63]
  v_mfma_f32_16x16x32_bf16 v[64:67], v[228:231], v[172:175], v[64:67]
  v_mfma_f32_16x16x32_bf16 v[68:71], v[232:235], v[172:175], v[68:71]
  v_mfma_f32_16x16x32_bf16 v[72:75], v[236:239], v[172:175], v[72:75]
  v_mfma_f32_16x16x32_bf16 v[76:79], v[224:227], v[176:179], v[76:79]
  v_mfma_f32_16x16x32_bf16 v[80:83], v[228:231], v[176:179], v[80:83]
  v_mfma_f32_16x16x32_bf16 v[84:87], v[232:235], v[176:179], v[84:87]
  v_mfma_f32_16x16x32_bf16 v[88:91], v[236:239], v[176:179], v[88:91]
  v_mfma_f32_16x16x32_bf16 v[92:95], v[224:227], v[180:183], v[92:95]
  v_mfma_f32_16x16x32_bf16 v[96:99], v[228:231], v[180:183], v[96:99]
  v_mfma_f32_16x16x32_bf16 v[100:103], v[232:235], v[180:183], v[100:103]
  v_mfma_f32_16x16x32_bf16 v[104:107], v[236:239], v[180:183], v[104:107]
  v_mfma_f32_16x16x32_bf16 v[108:111], v[224:227], v[196:199], v[108:111]
  v_mfma_f32_16x16x32_bf16 v[112:115], v[228:231], v[196:199], v[112:115]
  v_mfma_f32_16x16x32_bf16 v[116:119], v[232:235], v[196:199], v[116:119]
  v_mfma_f32_16x16x32_bf16 v[120:123], v[236:239], v[196:199], v[120:123]
  v_mfma_f32_16x16x32_bf16 v[124:127], v[224:227], v[200:203], v[124:127]
  v_mfma_f32_16x16x32_bf16 v[128:131], v[228:231], v[200:203], v[128:131]
  v_mfma_f32_16x16x32_bf16 v[132:135], v[232:235], v[200:203], v[132:135]
  v_mfma_f32_16x16x32_bf16 v[136:139], v[236:239], v[200:203], v[136:139]
  v_mfma_f32_16x16x32_bf16 v[140:143], v[224:227], v[204:207], v[140:143]
  v_mfma_f32_16x16x32_bf16 v[144:147], v[228:231], v[204:207], v[144:147]
  v_mfma_f32_16x16x32_bf16 v[148:151], v[232:235], v[204:207], v[148:151]
  v_mfma_f32_16x16x32_bf16 v[152:155], v[236:239], v[204:207], v[152:155]
  s_nop 7
  s_cmp_eq_u32 s28, 1
  s_cbranch_scc1 L_proj_kernel_eBK
  s_add_u32 s30, s43, 0
  v_pk_mul_f32 v[28:29], v[28:29], s[56:57]
  v_pk_mul_f32 v[30:31], v[30:31], s[56:57]
  v_pk_mul_f32 v[32:33], v[32:33], s[56:57]
  v_pk_mul_f32 v[34:35], v[34:35], s[56:57]
  v_cvt_pk_bf16_f32 v164, v28, v29
  v_cvt_pk_bf16_f32 v165, v30, v31
  v_cvt_pk_bf16_f32 v166, v32, v33
  v_cvt_pk_bf16_f32 v167, v34, v35
  buffer_store_dwordx4 v[164:167], v16, s[20:23], s30 offen offset:0 sc0 sc1
  v_pk_mul_f32 v[44:45], v[44:45], s[56:57]
  v_pk_mul_f32 v[46:47], v[46:47], s[56:57]
  v_pk_mul_f32 v[48:49], v[48:49], s[56:57]
  v_pk_mul_f32 v[50:51], v[50:51], s[56:57]
  v_cvt_pk_bf16_f32 v168, v44, v45
  v_cvt_pk_bf16_f32 v169, v46, v47
  v_cvt_pk_bf16_f32 v170, v48, v49
  v_cvt_pk_bf16_f32 v171, v50, v51
  buffer_store_dwordx4 v[168:171], v16, s[20:23], s30 offen offset:256 sc0 sc1
  s_add_u32 s30, s43, 2048
  v_pk_mul_f32 v[60:61], v[60:61], s[56:57]
  v_pk_mul_f32 v[62:63], v[62:63], s[56:57]
  v_pk_mul_f32 v[64:65], v[64:65], s[56:57]
  v_pk_mul_f32 v[66:67], v[66:67], s[56:57]
  v_cvt_pk_bf16_f32 v172, v60, v61
  v_cvt_pk_bf16_f32 v173, v62, v63
  v_cvt_pk_bf16_f32 v174, v64, v65
  v_cvt_pk_bf16_f32 v175, v66, v67
  buffer_store_dwordx4 v[172:175], v16, s[20:23], s30 offen offset:0 sc0 sc1
  v_pk_mul_f32 v[76:77], v[76:77], s[56:57]
  v_pk_mul_f32 v[78:79], v[78:79], s[56:57]
  v_pk_mul_f32 v[80:81], v[80:81], s[56:57]
  v_pk_mul_f32 v[82:83], v[82:83], s[56:57]
  v_cvt_pk_bf16_f32 v176, v76, v77
  v_cvt_pk_bf16_f32 v177, v78, v79
  v_cvt_pk_bf16_f32 v178, v80, v81
  v_cvt_pk_bf16_f32 v179, v82, v83
  buffer_store_dwordx4 v[176:179], v16, s[20:23], s30 offen offset:256 sc0 sc1
  s_add_u32 s30, s43, 4096
  v_pk_mul_f32 v[92:93], v[92:93], s[56:57]
  v_pk_mul_f32 v[94:95], v[94:95], s[56:57]
  v_pk_mul_f32 v[96:97], v[96:97], s[56:57]
  v_pk_mul_f32 v[98:99], v[98:99], s[56:57]
  v_cvt_pk_bf16_f32 v164, v92, v93
  v_cvt_pk_bf16_f32 v165, v94, v95
  v_cvt_pk_bf16_f32 v166, v96, v97
  v_cvt_pk_bf16_f32 v167, v98, v99
  buffer_store_dwordx4 v[164:167], v16, s[20:23], s30 offen offset:0 sc0 sc1
  v_pk_mul_f32 v[108:109], v[108:109], s[56:57]
  v_pk_mul_f32 v[110:111], v[110:111], s[56:57]
  v_pk_mul_f32 v[112:113], v[112:113], s[56:57]
  v_pk_mul_f32 v[114:115], v[114:115], s[56:57]
  v_cvt_pk_bf16_f32 v168, v108, v109
  v_cvt_pk_bf16_f32 v169, v110, v111
  v_cvt_pk_bf16_f32 v170, v112, v113
  v_cvt_pk_bf16_f32 v171, v114, v115
  buffer_store_dwordx4 v[168:171], v16, s[20:23], s30 offen offset:256 sc0 sc1
  s_add_u32 s30, s43, 6144
  v_pk_mul_f32 v[124:125], v[124:125], s[56:57]
  v_pk_mul_f32 v[126:127], v[126:127], s[56:57]
  v_pk_mul_f32 v[128:129], v[128:129], s[56:57]
  v_pk_mul_f32 v[130:131], v[130:131], s[56:57]
  v_cvt_pk_bf16_f32 v172, v124, v125
  v_cvt_pk_bf16_f32 v173, v126, v127
  v_cvt_pk_bf16_f32 v174, v128, v129
  v_cvt_pk_bf16_f32 v175, v130, v131
  buffer_store_dwordx4 v[172:175], v16, s[20:23], s30 offen offset:0 sc0 sc1
  v_pk_mul_f32 v[140:141], v[140:141], s[56:57]
  v_pk_mul_f32 v[142:143], v[142:143], s[56:57]
  v_pk_mul_f32 v[144:145], v[144:145], s[56:57]
  v_pk_mul_f32 v[146:147], v[146:147], s[56:57]
  v_cvt_pk_bf16_f32 v176, v140, v141
  v_cvt_pk_bf16_f32 v177, v142, v143
  v_cvt_pk_bf16_f32 v178, v144, v145
  v_cvt_pk_bf16_f32 v179, v146, v147
  buffer_store_dwordx4 v[176:179], v16, s[20:23], s30 offen offset:256 sc0 sc1
  s_add_u32 s30, s43, 131072
  v_pk_mul_f32 v[36:37], v[36:37], s[56:57]
  v_pk_mul_f32 v[38:39], v[38:39], s[56:57]
  v_pk_mul_f32 v[40:41], v[40:41], s[56:57]
  v_pk_mul_f32 v[42:43], v[42:43], s[56:57]
  v_cvt_pk_bf16_f32 v164, v36, v37
  v_cvt_pk_bf16_f32 v165, v38, v39
  v_cvt_pk_bf16_f32 v166, v40, v41
  v_cvt_pk_bf16_f32 v167, v42, v43
  buffer_store_dwordx4 v[164:167], v16, s[20:23], s30 offen offset:0 sc0 sc1
  v_pk_mul_f32 v[52:53], v[52:53], s[56:57]
  v_pk_mul_f32 v[54:55], v[54:55], s[56:57]
  v_pk_mul_f32 v[56:57], v[56:57], s[56:57]
  v_pk_mul_f32 v[58:59], v[58:59], s[56:57]
  v_cvt_pk_bf16_f32 v168, v52, v53
  v_cvt_pk_bf16_f32 v169, v54, v55
  v_cvt_pk_bf16_f32 v170, v56, v57
  v_cvt_pk_bf16_f32 v171, v58, v59
  buffer_store_dwordx4 v[168:171], v16, s[20:23], s30 offen offset:256 sc0 sc1
  s_add_u32 s30, s43, 133120
  v_pk_mul_f32 v[68:69], v[68:69], s[56:57]
  v_pk_mul_f32 v[70:71], v[70:71], s[56:57]
  v_pk_mul_f32 v[72:73], v[72:73], s[56:57]
  v_pk_mul_f32 v[74:75], v[74:75], s[56:57]
  v_cvt_pk_bf16_f32 v172, v68, v69
  v_cvt_pk_bf16_f32 v173, v70, v71
  v_cvt_pk_bf16_f32 v174, v72, v73
  v_cvt_pk_bf16_f32 v175, v74, v75
  buffer_store_dwordx4 v[172:175], v16, s[20:23], s30 offen offset:0 sc0 sc1
  v_pk_mul_f32 v[84:85], v[84:85], s[56:57]
  v_pk_mul_f32 v[86:87], v[86:87], s[56:57]
  v_pk_mul_f32 v[88:89], v[88:89], s[56:57]
  v_pk_mul_f32 v[90:91], v[90:91], s[56:57]
  v_cvt_pk_bf16_f32 v176, v84, v85
  v_cvt_pk_bf16_f32 v177, v86, v87
  v_cvt_pk_bf16_f32 v178, v88, v89
  v_cvt_pk_bf16_f32 v179, v90, v91
  buffer_store_dwordx4 v[176:179], v16, s[20:23], s30 offen offset:256 sc0 sc1
  s_add_u32 s30, s43, 135168
  v_pk_mul_f32 v[100:101], v[100:101], s[56:57]
  v_pk_mul_f32 v[102:103], v[102:103], s[56:57]
  v_pk_mul_f32 v[104:105], v[104:105], s[56:57]
  v_pk_mul_f32 v[106:107], v[106:107], s[56:57]
  v_cvt_pk_bf16_f32 v164, v100, v101
  v_cvt_pk_bf16_f32 v165, v102, v103
  v_cvt_pk_bf16_f32 v166, v104, v105
  v_cvt_pk_bf16_f32 v167, v106, v107
  buffer_store_dwordx4 v[164:167], v16, s[20:23], s30 offen offset:0 sc0 sc1
  v_pk_mul_f32 v[116:117], v[116:117], s[56:57]
  v_pk_mul_f32 v[118:119], v[118:119], s[56:57]
  v_pk_mul_f32 v[120:121], v[120:121], s[56:57]
  v_pk_mul_f32 v[122:123], v[122:123], s[56:57]
  v_cvt_pk_bf16_f32 v168, v116, v117
  v_cvt_pk_bf16_f32 v169, v118, v119
  v_cvt_pk_bf16_f32 v170, v120, v121
  v_cvt_pk_bf16_f32 v171, v122, v123
  buffer_store_dwordx4 v[168:171], v16, s[20:23], s30 offen offset:256 sc0 sc1
  s_add_u32 s30, s43, 137216
  v_pk_mul_f32 v[132:133], v[132:133], s[56:57]
  v_pk_mul_f32 v[134:135], v[134:135], s[56:57]
  v_pk_mul_f32 v[136:137], v[136:137], s[56:57]
  v_pk_mul_f32 v[138:139], v[138:139], s[56:57]
  v_cvt_pk_bf16_f32 v172, v132, v133
  v_cvt_pk_bf16_f32 v173, v134, v135
  v_cvt_pk_bf16_f32 v174, v136, v137
  v_cvt_pk_bf16_f32 v175, v138, v139
  buffer_store_dwordx4 v[172:175], v16, s[20:23], s30 offen offset:0 sc0 sc1
  v_pk_mul_f32 v[148:149], v[148:149], s[56:57]
  v_pk_mul_f32 v[150:151], v[150:151], s[56:57]
  v_pk_mul_f32 v[152:153], v[152:153], s[56:57]
  v_pk_mul_f32 v[154:155], v[154:155], s[56:57]
  v_cvt_pk_bf16_f32 v176, v148, v149
  v_cvt_pk_bf16_f32 v177, v150, v151
  v_cvt_pk_bf16_f32 v178, v152, v153
  v_cvt_pk_bf16_f32 v179, v154, v155
  buffer_store_dwordx4 v[176:179], v16, s[20:23], s30 offen offset:256 sc0 sc1
  s_branch L_proj_kernel_done
L_proj_kernel_eBK:
  s_add_u32 s30, s43, 0
  v_cvt_pk_bf16_f32 v164, v28, v29
  v_cvt_pk_bf16_f32 v165, v30, v31
  v_cvt_pk_bf16_f32 v166, v32, v33
  v_cvt_pk_bf16_f32 v167, v34, v35
  buffer_store_dwordx4 v[164:167], v16, s[20:23], s30 offen offset:0 sc0 sc1
  v_cvt_pk_bf16_f32 v168, v44, v45
  v_cvt_pk_bf16_f32 v169, v46, v47
  v_cvt_pk_bf16_f32 v170, v48, v49
  v_cvt_pk_bf16_f32 v171, v50, v51
  buffer_store_dwordx4 v[168:171], v16, s[20:23], s30 offen offset:256 sc0 sc1
  s_add_u32 s30, s43, 2048
  v_cvt_pk_bf16_f32 v172, v60, v61
  v_cvt_pk_bf16_f32 v173, v62, v63
  v_cvt_pk_bf16_f32 v174, v64, v65
  v_cvt_pk_bf16_f32 v175, v66, v67
  buffer_store_dwordx4 v[172:175], v16, s[20:23], s30 offen offset:0 sc0 sc1
  v_cvt_pk_bf16_f32 v176, v76, v77
  v_cvt_pk_bf16_f32 v177, v78, v79
  v_cvt_pk_bf16_f32 v178, v80, v81
  v_cvt_pk_bf16_f32 v179, v82, v83
  buffer_store_dwordx4 v[176:179], v16, s[20:23], s30 offen offset:256 sc0 sc1
  s_add_u32 s30, s43, 4096
  v_cvt_pk_bf16_f32 v164, v92, v93
  v_cvt_pk_bf16_f32 v165, v94, v95
  v_cvt_pk_bf16_f32 v166, v96, v97
  v_cvt_pk_bf16_f32 v167, v98, v99
  buffer_store_dwordx4 v[164:167], v16, s[20:23], s30 offen offset:0 sc0 sc1
  v_cvt_pk_bf16_f32 v168, v108, v109
  v_cvt_pk_bf16_f32 v169, v110, v111
  v_cvt_pk_bf16_f32 v170, v112, v113
  v_cvt_pk_bf16_f32 v171, v114, v115
  buffer_store_dwordx4 v[168:171], v16, s[20:23], s30 offen offset:256 sc0 sc1
  s_add_u32 s30, s43, 6144
  v_cvt_pk_bf16_f32 v172, v124, v125
  v_cvt_pk_bf16_f32 v173, v126, v127
  v_cvt_pk_bf16_f32 v174, v128, v129
  v_cvt_pk_bf16_f32 v175, v130, v131
  buffer_store_dwordx4 v[172:175], v16, s[20:23], s30 offen offset:0 sc0 sc1
  v_cvt_pk_bf16_f32 v176, v140, v141
  v_cvt_pk_bf16_f32 v177, v142, v143
  v_cvt_pk_bf16_f32 v178, v144, v145
  v_cvt_pk_bf16_f32 v179, v146, v147
  buffer_store_dwordx4 v[176:179], v16, s[20:23], s30 offen offset:256 sc0 sc1
  s_add_u32 s30, s43, 131072
  v_cvt_pk_bf16_f32 v164, v36, v37
  v_cvt_pk_bf16_f32 v165, v38, v39
  v_cvt_pk_bf16_f32 v166, v40, v41
  v_cvt_pk_bf16_f32 v167, v42, v43
  buffer_store_dwordx4 v[164:167], v16, s[20:23], s30 offen offset:0 sc0 sc1
  v_cvt_pk_bf16_f32 v168, v52, v53
  v_cvt_pk_bf16_f32 v169, v54, v55
  v_cvt_pk_bf16_f32 v170, v56, v57
  v_cvt_pk_bf16_f32 v171, v58, v59
  buffer_store_dwordx4 v[168:171], v16, s[20:23], s30 offen offset:256 sc0 sc1
  s_add_u32 s30, s43, 133120
  v_cvt_pk_bf16_f32 v172, v68, v69
  v_cvt_pk_bf16_f32 v173, v70, v71
  v_cvt_pk_bf16_f32 v174, v72, v73
  v_cvt_pk_bf16_f32 v175, v74, v75
  buffer_store_dwordx4 v[172:175], v16, s[20:23], s30 offen offset:0 sc0 sc1
  v_cvt_pk_bf16_f32 v176, v84, v85
  v_cvt_pk_bf16_f32 v177, v86, v87
  v_cvt_pk_bf16_f32 v178, v88, v89
  v_cvt_pk_bf16_f32 v179, v90, v91
  buffer_store_dwordx4 v[176:179], v16, s[20:23], s30 offen offset:256 sc0 sc1
  s_add_u32 s30, s43, 135168
  v_cvt_pk_bf16_f32 v164, v100, v101
  v_cvt_pk_bf16_f32 v165, v102, v103
  v_cvt_pk_bf16_f32 v166, v104, v105
  v_cvt_pk_bf16_f32 v167, v106, v107
  buffer_store_dwordx4 v[164:167], v16, s[20:23], s30 offen offset:0 sc0 sc1
  v_cvt_pk_bf16_f32 v168, v116, v117
  v_cvt_pk_bf16_f32 v169, v118, v119
  v_cvt_pk_bf16_f32 v170, v120, v121
  v_cvt_pk_bf16_f32 v171, v122, v123
  buffer_store_dwordx4 v[168:171], v16, s[20:23], s30 offen offset:256 sc0 sc1
  s_add_u32 s30, s43, 137216
  v_cvt_pk_bf16_f32 v172, v132, v133
  v_cvt_pk_bf16_f32 v173, v134, v135
  v_cvt_pk_bf16_f32 v174, v136, v137
  v_cvt_pk_bf16_f32 v175, v138, v139
  buffer_store_dwordx4 v[172:175], v16, s[20:23], s30 offen offset:0 sc0 sc1
  v_cvt_pk_bf16_f32 v176, v148, v149
  v_cvt_pk_bf16_f32 v177, v150, v151
  v_cvt_pk_bf16_f32 v178, v152, v153
  v_cvt_pk_bf16_f32 v179, v154, v155
  buffer_store_dwordx4 v[176:179], v16, s[20:23], s30 offen offset:256 sc0 sc1
  s_branch L_proj_kernel_done
L_proj_kernel_cBV:
  s_lshl_b32 s43, s30, 11
  s_add_u32 s43, s43, 12582912
  ds_read_b64_tr_b16 v[208:209], v8 offset:0
  ds_read_b64_tr_b16 v[210:211], v8 offset:2048
  ds_read_b64_tr_b16 v[212:213], v9 offset:0
  ds_read_b64_tr_b16 v[214:215], v9 offset:2048
  ds_read_b64_tr_b16 v[216:217], v10 offset:0
  ds_read_b64_tr_b16 v[218:219], v10 offset:2048
  ds_read_b64_tr_b16 v[220:221], v11 offset:0
  ds_read_b64_tr_b16 v[222:223], v11 offset:2048
  s_waitcnt lgkmcnt(4)
  ds_read_b128 v[164:167], v6 offset:0
  ds_read_b128 v[168:171], v7 offset:1024
  ds_read_b128 v[172:175], v6 offset:4096
  ds_read_b128 v[176:179], v7 offset:5120
  ds_read_b128 v[180:183], v6 offset:8192
  ds_read_b128 v[184:187], v7 offset:9216
  ds_read_b128 v[188:191], v6 offset:12288
  ds_read_b128 v[192:195], v7 offset:13312
  s_mov_b32 s34, 15
  .p2align 6
L_proj_kernel_bv_loop:
  s_waitcnt lgkmcnt(0)
  v_mfma_f32_16x16x32_bf16 v[28:31], v[164:167], v[208:211], v[28:31]
  ds_read_b64_tr_b16 v[224:225], v8 offset:16384
  v_mfma_f32_16x16x32_bf16 v[32:35], v[164:167], v[212:215], v[32:35]
  ds_read_b64_tr_b16 v[226:227], v8 offset:18432
  v_mfma_f32_16x16x32_bf16 v[36:39], v[164:167], v[216:219], v[36:39]
  ds_read_b64_tr_b16 v[228:229], v9 offset:16384
  v_mfma_f32_16x16x32_bf16 v[40:43], v[164:167], v[220:223], v[40:43]
  ds_read_b64_tr_b16 v[230:231], v9 offset:18432
  ds_read_b128 v[164:167], v7 offset:0
  v_mfma_f32_16x16x32_bf16 v[44:47], v[168:171], v[208:211], v[44:47]
  ds_read_b64_tr_b16 v[232:233], v10 offset:16384
  v_mfma_f32_16x16x32_bf16 v[48:51], v[168:171], v[212:215], v[48:51]
  ds_read_b64_tr_b16 v[234:235], v10 offset:18432
  v_mfma_f32_16x16x32_bf16 v[52:55], v[168:171], v[216:219], v[52:55]
  ds_read_b64_tr_b16 v[236:237], v11 offset:16384
  v_mfma_f32_16x16x32_bf16 v[56:59], v[168:171], v[220:223], v[56:59]
  ds_read_b64_tr_b16 v[238:239], v11 offset:18432
  ds_read_b128 v[168:171], v6 offset:1024
  v_mfma_f32_16x16x32_bf16 v[60:63], v[172:175], v[208:211], v[60:63]
  ds_read_b128 v[196:199], v6 offset:9216
  v_mfma_f32_16x16x32_bf16 v[64:67], v[172:175], v[212:215], v[64:67]
  ds_read_b128 v[200:203], v7 offset:12288
  v_mfma_f32_16x16x32_bf16 v[68:71], v[172:175], v[216:219], v[68:71]
  ds_read_b128 v[204:207], v6 offset:13312
  v_mfma_f32_16x16x32_bf16 v[72:75], v[172:175], v[220:223], v[72:75]
  ds_read_b128 v[172:175], v7 offset:4096
  v_mfma_f32_16x16x32_bf16 v[76:79], v[176:179], v[208:211], v[76:79]
  s_add_u32 s36, s36, 1
  v_mfma_f32_16x16x32_bf16 v[80:83], v[176:179], v[212:215], v[80:83]
  s_cmp_eq_u32 s36, 3
  v_mfma_f32_16x16x32_bf16 v[84:87], v[176:179], v[216:219], v[84:87]
  s_cselect_b32 s35, s45, 51200
  v_mfma_f32_16x16x32_bf16 v[88:91], v[176:179], v[220:223], v[88:91]
  ds_read_b128 v[176:179], v6 offset:5120
  v_mfma_f32_16x16x32_bf16 v[92:95], v[180:183], v[208:211], v[92:95]
  s_cselect_b32 s36, 0, s36
  v_mfma_f32_16x16x32_bf16 v[96:99], v[180:183], v[212:215], v[96:99]
  v_mfma_f32_16x16x32_bf16 v[100:103], v[180:183], v[216:219], v[100:103]
  v_mfma_f32_16x16x32_bf16 v[104:107], v[180:183], v[220:223], v[104:107]
  ds_read_b128 v[180:183], v7 offset:8192
  v_mfma_f32_16x16x32_bf16 v[108:111], v[184:187], v[208:211], v[108:111]
  v_add_u32 v6, s35, v6
  v_mfma_f32_16x16x32_bf16 v[112:115], v[184:187], v[212:215], v[112:115]
  v_add_u32 v7, s35, v7
  v_mfma_f32_16x16x32_bf16 v[116:119], v[184:187], v[216:219], v[116:119]
  v_add_u32 v8, s35, v8
  v_mfma_f32_16x16x32_bf16 v[120:123], v[184:187], v[220:223], v[120:123]
  v_add_u32 v9, s35, v9
  v_mfma_f32_16x16x32_bf16 v[124:127], v[188:191], v[208:211], v[124:127]
  v_add_u32 v10, s35, v10
  v_mfma_f32_16x16x32_bf16 v[128:131], v[188:191], v[212:215], v[128:131]
  v_add_u32 v11, s35, v11
  v_mfma_f32_16x16x32_bf16 v[132:135], v[188:191], v[216:219], v[132:135]
  v_mfma_f32_16x16x32_bf16 v[136:139], v[188:191], v[220:223], v[136:139]
  v_mfma_f32_16x16x32_bf16 v[140:143], v[192:195], v[208:211], v[140:143]
  v_mfma_f32_16x16x32_bf16 v[144:147], v[192:195], v[212:215], v[144:147]
  v_mfma_f32_16x16x32_bf16 v[148:151], v[192:195], v[216:219], v[148:151]
  v_mfma_f32_16x16x32_bf16 v[152:155], v[192:195], v[220:223], v[152:155]
  s_waitcnt lgkmcnt(0)
  s_barrier
  v_mfma_f32_16x16x32_bf16 v[28:31], v[164:167], v[224:227], v[28:31]
  ds_read_b64_tr_b16 v[208:209], v8 offset:0
  v_mfma_f32_16x16x32_bf16 v[32:35], v[164:167], v[228:231], v[32:35]
  ds_read_b64_tr_b16 v[210:211], v8 offset:2048
  v_mfma_f32_16x16x32_bf16 v[36:39], v[164:167], v[232:235], v[36:39]
  ds_read_b64_tr_b16 v[212:213], v9 offset:0
  v_mfma_f32_16x16x32_bf16 v[40:43], v[164:167], v[236:239], v[40:43]
  ds_read_b64_tr_b16 v[214:215], v9 offset:2048
  ds_read_b128 v[164:167], v6 offset:0
  v_mfma_f32_16x16x32_bf16 v[44:47], v[168:171], v[224:227], v[44:47]
  ds_read_b64_tr_b16 v[216:217], v10 offset:0
  v_mfma_f32_16x16x32_bf16 v[48:51], v[168:171], v[228:231], v[48:51]
  ds_read_b64_tr_b16 v[218:219], v10 offset:2048
  v_mfma_f32_16x16x32_bf16 v[52:55], v[168:171], v[232:235], v[52:55]
  ds_read_b64_tr_b16 v[220:221], v11 offset:0
  v_mfma_f32_16x16x32_bf16 v[56:59], v[168:171], v[236:239], v[56:59]
  ds_read_b64_tr_b16 v[222:223], v11 offset:2048
  ds_read_b128 v[168:171], v7 offset:1024
  v_mfma_f32_16x16x32_bf16 v[60:63], v[172:175], v[224:227], v[60:63]
  ds_read_b128 v[184:187], v7 offset:9216
  v_mfma_f32_16x16x32_bf16 v[64:67], v[172:175], v[228:231], v[64:67]
  ds_read_b128 v[188:191], v6 offset:12288
  v_mfma_f32_16x16x32_bf16 v[68:71], v[172:175], v[232:235], v[68:71]
  ds_read_b128 v[192:195], v7 offset:13312
  v_mfma_f32_16x16x32_bf16 v[72:75], v[172:175], v[236:239], v[72:75]
  ds_read_b128 v[172:175], v6 offset:4096
  v_mfma_f32_16x16x32_bf16 v[76:79], v[176:179], v[224:227], v[76:79]
  v_mfma_f32_16x16x32_bf16 v[80:83], v[176:179], v[228:231], v[80:83]
  v_mfma_f32_16x16x32_bf16 v[84:87], v[176:179], v[232:235], v[84:87]
  v_mfma_f32_16x16x32_bf16 v[88:91], v[176:179], v[236:239], v[88:91]
  ds_read_b128 v[176:179], v7 offset:5120
  v_mfma_f32_16x16x32_bf16 v[92:95], v[180:183], v[224:227], v[92:95]
  v_mfma_f32_16x16x32_bf16 v[96:99], v[180:183], v[228:231], v[96:99]
  v_mfma_f32_16x16x32_bf16 v[100:103], v[180:183], v[232:235], v[100:103]
  v_mfma_f32_16x16x32_bf16 v[104:107], v[180:183], v[236:239], v[104:107]
  ds_read_b128 v[180:183], v6 offset:8192
  v_mfma_f32_16x16x32_bf16 v[108:111], v[196:199], v[224:227], v[108:111]
  s_sub_u32 s34, s34, 1
  v_mfma_f32_16x16x32_bf16 v[112:115], v[196:199], v[228:231], v[112:115]
  s_cmp_lg_u32 s34, 0
  v_mfma_f32_16x16x32_bf16 v[116:119], v[196:199], v[232:235], v[116:119]
  v_mfma_f32_16x16x32_bf16 v[120:123], v[196:199], v[236:239], v[120:123]
  v_mfma_f32_16x16x32_bf16 v[124:127], v[200:203], v[224:227], v[124:127]
  v_mfma_f32_16x16x32_bf16 v[128:131], v[200:203], v[228:231], v[128:131]
  v_mfma_f32_16x16x32_bf16 v[132:135], v[200:203], v[232:235], v[132:135]
  v_mfma_f32_16x16x32_bf16 v[136:139], v[200:203], v[236:239], v[136:139]
  v_mfma_f32_16x16x32_bf16 v[140:143], v[204:207], v[224:227], v[140:143]
  v_mfma_f32_16x16x32_bf16 v[144:147], v[204:207], v[228:231], v[144:147]
  v_mfma_f32_16x16x32_bf16 v[148:151], v[204:207], v[232:235], v[148:151]
  v_mfma_f32_16x16x32_bf16 v[152:155], v[204:207], v[236:239], v[152:155]
  s_cbranch_scc1 L_proj_kernel_bv_loop
  s_cmp_lg_u32 s3, 0
  s_cbranch_scc1 L_proj_kernel_bv_notag
  global_load_dwordx2 v[26:27], v24, s[98:99] sc0 sc1
L_proj_kernel_bv_notag:
  s_waitcnt lgkmcnt(0)
  v_mfma_f32_16x16x32_bf16 v[28:31], v[164:167], v[208:211], v[28:31]
  ds_read_b64_tr_b16 v[224:225], v8 offset:16384
  v_mfma_f32_16x16x32_bf16 v[32:35], v[164:167], v[212:215], v[32:35]
  ds_read_b64_tr_b16 v[226:227], v8 offset:18432
  v_mfma_f32_16x16x32_bf16 v[36:39], v[164:167], v[216:219], v[36:39]
  ds_read_b64_tr_b16 v[228:229], v9 offset:16384
  v_mfma_f32_16x16x32_bf16 v[40:43], v[164:167], v[220:223], v[40:43]
  ds_read_b64_tr_b16 v[230:231], v9 offset:18432
  ds_read_b128 v[164:167], v7 offset:0
  v_mfma_f32_16x16x32_bf16 v[44:47], v[168:171], v[208:211], v[44:47]
  ds_read_b64_tr_b16 v[232:233], v10 offset:16384
  v_mfma_f32_16x16x32_bf16 v[48:51], v[168:171], v[212:215], v[48:51]
  ds_read_b64_tr_b16 v[234:235], v10 offset:18432
  v_mfma_f32_16x16x32_bf16 v[52:55], v[168:171], v[216:219], v[52:55]
  ds_read_b64_tr_b16 v[236:237], v11 offset:16384
  v_mfma_f32_16x16x32_bf16 v[56:59], v[168:171], v[220:223], v[56:59]
  ds_read_b64_tr_b16 v[238:239], v11 offset:18432
  ds_read_b128 v[168:171], v6 offset:1024
  v_mfma_f32_16x16x32_bf16 v[60:63], v[172:175], v[208:211], v[60:63]
  ds_read_b128 v[196:199], v6 offset:9216
  v_mfma_f32_16x16x32_bf16 v[64:67], v[172:175], v[212:215], v[64:67]
  ds_read_b128 v[200:203], v7 offset:12288
  v_mfma_f32_16x16x32_bf16 v[68:71], v[172:175], v[216:219], v[68:71]
  ds_read_b128 v[204:207], v6 offset:13312
  v_mfma_f32_16x16x32_bf16 v[72:75], v[172:175], v[220:223], v[72:75]
  ds_read_b128 v[172:175], v7 offset:4096
  v_mfma_f32_16x16x32_bf16 v[76:79], v[176:179], v[208:211], v[76:79]
  v_mfma_f32_16x16x32_bf16 v[80:83], v[176:179], v[212:215], v[80:83]
  v_mfma_f32_16x16x32_bf16 v[84:87], v[176:179], v[216:219], v[84:87]
  v_mfma_f32_16x16x32_bf16 v[88:91], v[176:179], v[220:223], v[88:91]
  ds_read_b128 v[176:179], v6 offset:5120
  v_mfma_f32_16x16x32_bf16 v[92:95], v[180:183], v[208:211], v[92:95]
  v_mfma_f32_16x16x32_bf16 v[96:99], v[180:183], v[212:215], v[96:99]
  v_mfma_f32_16x16x32_bf16 v[100:103], v[180:183], v[216:219], v[100:103]
  v_mfma_f32_16x16x32_bf16 v[104:107], v[180:183], v[220:223], v[104:107]
  ds_read_b128 v[180:183], v7 offset:8192
  v_mfma_f32_16x16x32_bf16 v[108:111], v[184:187], v[208:211], v[108:111]
  v_mfma_f32_16x16x32_bf16 v[112:115], v[184:187], v[212:215], v[112:115]
  v_mfma_f32_16x16x32_bf16 v[116:119], v[184:187], v[216:219], v[116:119]
  v_mfma_f32_16x16x32_bf16 v[120:123], v[184:187], v[220:223], v[120:123]
  v_mfma_f32_16x16x32_bf16 v[124:127], v[188:191], v[208:211], v[124:127]
  v_mfma_f32_16x16x32_bf16 v[128:131], v[188:191], v[212:215], v[128:131]
  v_mfma_f32_16x16x32_bf16 v[132:135], v[188:191], v[216:219], v[132:135]
  v_mfma_f32_16x16x32_bf16 v[136:139], v[188:191], v[220:223], v[136:139]
  v_mfma_f32_16x16x32_bf16 v[140:143], v[192:195], v[208:211], v[140:143]
  v_mfma_f32_16x16x32_bf16 v[144:147], v[192:195], v[212:215], v[144:147]
  v_mfma_f32_16x16x32_bf16 v[148:151], v[192:195], v[216:219], v[148:151]
  v_mfma_f32_16x16x32_bf16 v[152:155], v[192:195], v[220:223], v[152:155]
  s_waitcnt lgkmcnt(0)
  v_mfma_f32_16x16x32_bf16 v[28:31], v[164:167], v[224:227], v[28:31]
  v_mfma_f32_16x16x32_bf16 v[32:35], v[164:167], v[228:231], v[32:35]
  v_mfma_f32_16x16x32_bf16 v[36:39], v[164:167], v[232:235], v[36:39]
  v_mfma_f32_16x16x32_bf16 v[40:43], v[164:167], v[236:239], v[40:43]
  v_mfma_f32_16x16x32_bf16 v[44:47], v[168:171], v[224:227], v[44:47]
  v_mfma_f32_16x16x32_bf16 v[48:51], v[168:171], v[228:231], v[48:51]
  v_mfma_f32_16x16x32_bf16 v[52:55], v[168:171], v[232:235], v[52:55]
  v_mfma_f32_16x16x32_bf16 v[56:59], v[168:171], v[236:239], v[56:59]
  v_mfma_f32_16x16x32_bf16 v[60:63], v[172:175], v[224:227], v[60:63]
  v_mfma_f32_16x16x32_bf16 v[64:67], v[172:175], v[228:231], v[64:67]
  v_mfma_f32_16x16x32_bf16 v[68:71], v[172:175], v[232:235], v[68:71]
  v_mfma_f32_16x16x32_bf16 v[72:75], v[172:175], v[236:239], v[72:75]
  v_mfma_f32_16x16x32_bf16 v[76:79], v[176:179], v[224:227], v[76:79]
  v_mfma_f32_16x16x32_bf16 v[80:83], v[176:179], v[228:231], v[80:83]
  v_mfma_f32_16x16x32_bf16 v[84:87], v[176:179], v[232:235], v[84:87]
  v_mfma_f32_16x16x32_bf16 v[88:91], v[176:179], v[236:239], v[88:91]
  v_mfma_f32_16x16x32_bf16 v[92:95], v[180:183], v[224:227], v[92:95]
  v_mfma_f32_16x16x32_bf16 v[96:99], v[180:183], v[228:231], v[96:99]
  v_mfma_f32_16x16x32_bf16 v[100:103], v[180:183], v[232:235], v[100:103]
  v_mfma_f32_16x16x32_bf16 v[104:107], v[180:183], v[236:239], v[104:107]
  v_mfma_f32_16x16x32_bf16 v[108:111], v[196:199], v[224:227], v[108:111]
  v_mfma_f32_16x16x32_bf16 v[112:115], v[196:199], v[228:231], v[112:115]
  v_mfma_f32_16x16x32_bf16 v[116:119], v[196:199], v[232:235], v[116:119]
  v_mfma_f32_16x16x32_bf16 v[120:123], v[196:199], v[236:239], v[120:123]
  v_mfma_f32_16x16x32_bf16 v[124:127], v[200:203], v[224:227], v[124:127]
  v_mfma_f32_16x16x32_bf16 v[128:131], v[200:203], v[228:231], v[128:131]
  v_mfma_f32_16x16x32_bf16 v[132:135], v[200:203], v[232:235], v[132:135]
  v_mfma_f32_16x16x32_bf16 v[136:139], v[200:203], v[236:239], v[136:139]
  v_mfma_f32_16x16x32_bf16 v[140:143], v[204:207], v[224:227], v[140:143]
  v_mfma_f32_16x16x32_bf16 v[144:147], v[204:207], v[228:231], v[144:147]
  v_mfma_f32_16x16x32_bf16 v[148:151], v[204:207], v[232:235], v[148:151]
  v_mfma_f32_16x16x32_bf16 v[152:155], v[204:207], v[236:239], v[152:155]
  s_nop 7
  s_add_u32 s30, s43, 0
  v_cvt_pk_bf16_f32 v164, v28, v29
  v_cvt_pk_bf16_f32 v165, v30, v31
  v_cvt_pk_bf16_f32 v166, v44, v45
  v_cvt_pk_bf16_f32 v167, v46, v47
  buffer_store_dwordx4 v[164:167], v16, s[20:23], s30 offen offset:0 sc0 sc1
  v_cvt_pk_bf16_f32 v168, v32, v33
  v_cvt_pk_bf16_f32 v169, v34, v35
  v_cvt_pk_bf16_f32 v170, v48, v49
  v_cvt_pk_bf16_f32 v171, v50, v51
  buffer_store_dwordx4 v[168:171], v16, s[20:23], s30 offen offset:256 sc0 sc1
  s_add_u32 s30, s43, 2048
  v_cvt_pk_bf16_f32 v172, v60, v61
  v_cvt_pk_bf16_f32 v173, v62, v63
  v_cvt_pk_bf16_f32 v174, v76, v77
  v_cvt_pk_bf16_f32 v175, v78, v79
  buffer_store_dwordx4 v[172:175], v16, s[20:23], s30 offen offset:0 sc0 sc1
  v_cvt_pk_bf16_f32 v176, v64, v65
  v_cvt_pk_bf16_f32 v177, v66, v67
  v_cvt_pk_bf16_f32 v178, v80, v81
  v_cvt_pk_bf16_f32 v179, v82, v83
  buffer_store_dwordx4 v[176:179], v16, s[20:23], s30 offen offset:256 sc0 sc1
  s_add_u32 s30, s43, 4096
  v_cvt_pk_bf16_f32 v164, v92, v93
  v_cvt_pk_bf16_f32 v165, v94, v95
  v_cvt_pk_bf16_f32 v166, v108, v109
  v_cvt_pk_bf16_f32 v167, v110, v111
  buffer_store_dwordx4 v[164:167], v16, s[20:23], s30 offen offset:0 sc0 sc1
  v_cvt_pk_bf16_f32 v168, v96, v97
  v_cvt_pk_bf16_f32 v169, v98, v99
  v_cvt_pk_bf16_f32 v170, v112, v113
  v_cvt_pk_bf16_f32 v171, v114, v115
  buffer_store_dwordx4 v[168:171], v16, s[20:23], s30 offen offset:256 sc0 sc1
  s_add_u32 s30, s43, 6144
  v_cvt_pk_bf16_f32 v172, v124, v125
  v_cvt_pk_bf16_f32 v173, v126, v127
  v_cvt_pk_bf16_f32 v174, v140, v141
  v_cvt_pk_bf16_f32 v175, v142, v143
  buffer_store_dwordx4 v[172:175], v16, s[20:23], s30 offen offset:0 sc0 sc1
  v_cvt_pk_bf16_f32 v176, v128, v129
  v_cvt_pk_bf16_f32 v177, v130, v131
  v_cvt_pk_bf16_f32 v178, v144, v145
  v_cvt_pk_bf16_f32 v179, v146, v147
  buffer_store_dwordx4 v[176:179], v16, s[20:23], s30 offen offset:256 sc0 sc1
  s_add_u32 s30, s43, 131072
  v_cvt_pk_bf16_f32 v164, v36, v37
  v_cvt_pk_bf16_f32 v165, v38, v39
  v_cvt_pk_bf16_f32 v166, v52, v53
  v_cvt_pk_bf16_f32 v167, v54, v55
  buffer_store_dwordx4 v[164:167], v16, s[20:23], s30 offen offset:0 sc0 sc1
  v_cvt_pk_bf16_f32 v168, v40, v41
  v_cvt_pk_bf16_f32 v169, v42, v43
  v_cvt_pk_bf16_f32 v170, v56, v57
  v_cvt_pk_bf16_f32 v171, v58, v59
  buffer_store_dwordx4 v[168:171], v16, s[20:23], s30 offen offset:256 sc0 sc1
  s_add_u32 s30, s43, 133120
  v_cvt_pk_bf16_f32 v172, v68, v69
  v_cvt_pk_bf16_f32 v173, v70, v71
  v_cvt_pk_bf16_f32 v174, v84, v85
  v_cvt_pk_bf16_f32 v175, v86, v87
  buffer_store_dwordx4 v[172:175], v16, s[20:23], s30 offen offset:0 sc0 sc1
  v_cvt_pk_bf16_f32 v176, v72, v73
  v_cvt_pk_bf16_f32 v177, v74, v75
  v_cvt_pk_bf16_f32 v178, v88, v89
  v_cvt_pk_bf16_f32 v179, v90, v91
  buffer_store_dwordx4 v[176:179], v16, s[20:23], s30 offen offset:256 sc0 sc1
  s_add_u32 s30, s43, 135168
  v_cvt_pk_bf16_f32 v164, v100, v101
  v_cvt_pk_bf16_f32 v165, v102, v103
  v_cvt_pk_bf16_f32 v166, v116, v117
  v_cvt_pk_bf16_f32 v167, v118, v119
  buffer_store_dwordx4 v[164:167], v16, s[20:23], s30 offen offset:0 sc0 sc1
  v_cvt_pk_bf16_f32 v168, v104, v105
  v_cvt_pk_bf16_f32 v169, v106, v107
  v_cvt_pk_bf16_f32 v170, v120, v121
  v_cvt_pk_bf16_f32 v171, v122, v123
  buffer_store_dwordx4 v[168:171], v16, s[20:23], s30 offen offset:256 sc0 sc1
  s_add_u32 s30, s43, 137216
  v_cvt_pk_bf16_f32 v172, v132, v133
  v_cvt_pk_bf16_f32 v173, v134, v135
  v_cvt_pk_bf16_f32 v174, v148, v149
  v_cvt_pk_bf16_f32 v175, v150, v151
  buffer_store_dwordx4 v[172:175], v16, s[20:23], s30 offen offset:0 sc0 sc1
  v_cvt_pk_bf16_f32 v176, v136, v137
  v_cvt_pk_bf16_f32 v177, v138, v139
  v_cvt_pk_bf16_f32 v178, v152, v153
  v_cvt_pk_bf16_f32 v179, v154, v155
  buffer_store_dwordx4 v[176:179], v16, s[20:23], s30 offen offset:256 sc0 sc1
  s_branch L_proj_kernel_done
L_proj_kernel_done:
  s_waitcnt vmcnt(0)
  s_cmp_lg_u32 s3, 0
  s_cbranch_scc1 L_proj_kernel_lend
  s_mov_b32 s34, 400000
L_proj_kernel_tagspin:
  v_cmp_eq_u64 vcc, 0, v[26:27]
  s_sub_u32 s34, s34, 1
  s_nop 2
  s_cmp_eq_u64 vcc, 0
  s_cbranch_scc1 L_proj_kernel_tagok
  s_cmp_eq_u32 s34, 0
  s_cbranch_scc1 L_proj_kernel_tagok
  global_load_dwordx2 v[26:27], v24, s[98:99] sc0 sc1
  s_waitcnt vmcnt(0)
  s_branch L_proj_kernel_tagspin
L_proj_kernel_tagok:
  v_mov_b32 v1, 153600
  s_mov_b64 exec, 1
  ds_write_b64 v1, v[26:27]
  s_mov_b64 exec, -1
  s_waitcnt lgkmcnt(0)
L_proj_kernel_lend:
  s_barrier
  s_cmp_lg_u32 s3, 0
  s_cbranch_scc1 L_proj_kernel_noflag
  s_add_u32 s92, s54, 31457280
  s_addc_u32 s93, s55, 0
  s_and_b32 s93, s93, 0xffff
  s_mov_b32 s94, 393216
  s_mov_b32 s95, 0x20000
  v_mov_b32 v22, v26
  v_mov_b32 v23, v27
  s_mov_b32 s30, s2
  s_mul_i32 s30, s30, 1024
  s_add_u32 s30, s30, 0
  v_mbcnt_lo_u32_b32 v1, -1, 0
  v_mbcnt_hi_u32_b32 v1, -1, v1
  v_mov_b32 v24, v22
  v_mov_b32 v25, v23
  v_lshlrev_b32 v1, 4, v1
  buffer_store_dwordx4 v[22:25], v1, s[92:95], s30 offen sc0 sc1
L_proj_kernel_noflag:
  v_mov_b32 v1, 153600
  ds_read_b64 v[26:27], v1
  s_waitcnt lgkmcnt(0)
  v_readfirstlane_b32 s100, v26
  v_readfirstlane_b32 s101, v27
L_attn_code:
  s_load_dwordx2 s[4:5], s[0:1], 80
  v_and_b32 v1, 63, v0
  s_mov_b32 s16, s3
  v_lshlrev_b32 v1, 4, v1
  s_and_b32 s24, s2, 7
  s_lshr_b32 s25, s2, 3
  s_lshl_b32 s24, s24, 3
  s_lshr_b32 s26, s25, 2
  s_add_u32 s24, s24, s26
  s_and_b32 s25, s25, 3
  s_and_b32 s26, s24, 31
  s_lshr_b32 s24, s24, 5
  s_mov_b32 s28, s26
  s_mov_b32 s29, s24
  s_mov_b32 s30, s25
  s_cmp_lt_u32 s16, 4
  s_cbranch_scc1 L_attn_kernel_compute
L_attn_kernel_loader:
  s_sub_u32 s16, s16, 4
  s_lshl_b32 s26, s26, 17
  s_add_u32 s26, s26, 8388608
  s_cmp_eq_u32 s24, 0
  s_cselect_b32 s26, 16777216, s26
  s_mov_b32 s27, 4194304
  s_cselect_b32 s27, 131072, s27
  s_cmp_ge_u32 s16, 2
  s_cselect_b32 s27, s27, 0
  s_add_u32 s26, s26, s27
  s_and_b32 s25, s16, 1
  s_mul_i32 s25, s25, 8192
  v_add_u32 v20, s25, v1
  s_mul_i32 s18, s16, 8192
  s_mov_b32 s20, s18
  s_mov_b32 s17, 0
  s_waitcnt lgkmcnt(0)
  s_add_u32 s8, s4, s26
  s_addc_u32 s9, s5, 0
  s_and_b32 s9, s9, 0xffff
  s_mov_b32 s10, 131072
  s_mov_b32 s11, 0x20000
  s_cmp_lg_u32 s16, 0
  s_cbranch_scc1 L_attn_kernel_nopoll
  v_mov_b32 v132, s100
  v_mov_b32 v133, s101
  s_add_u32 s92, s4, 31457280
  s_addc_u32 s93, s5, 0
  s_and_b32 s93, s93, 0xffff
  s_mov_b32 s94, 393216
  s_mov_b32 s95, 0x20000
  v_lshrrev_b32 v4, 4, v1
  s_cmp_eq_u32 s29, 0
  s_cbranch_scc0 L_attn_kernel_pollB
  v_and_b32 v5, 1, v4
  v_lshrrev_b32 v6, 1, v4
  v_lshl_add_u32 v136, v6, 3, v5
  s_branch L_attn_kernel_pollgo
L_attn_kernel_pollB:
  v_and_b32 v5, 15, v4
  s_lshl_b32 s25, s30, 2
  v_and_b32 v6, 3, v4
  v_add_u32 v6, s25, v6
  v_cmp_gt_u32 vcc, 32, v4
  s_nop 1
  v_cndmask_b32 v5, v6, v5, vcc
  v_lshrrev_b32 v6, 4, v4
  v_lshlrev_b32 v6, 1, v6
  v_add_u32 v6, 4, v6
  v_cndmask_b32 v6, 2, v6, vcc
  v_lshrrev_b32 v7, 3, v5
  v_add_u32 v6, v6, v7
  v_and_b32 v5, 7, v5
  s_lshr_b32 s25, s28, 3
  s_lshl_b32 s25, s25, 3
  v_add_u32 v5, s25, v5
  v_lshl_add_u32 v136, v5, 3, v6
L_attn_kernel_pollgo:
  s_and_b32 s25, s2, 7
  s_lshl_b32 s25, s25, 7
  v_mul_u32_u24 v136, 1024, v136
  v_add_u32 v136, s25, v136
  s_cmp_eq_u32 s29, 0
  s_mov_b32 s19, 32768
  s_cselect_b32 exec_lo, 0, s19
  s_mov_b32 s19, 0
  s_cselect_b32 exec_hi, 2147483648, s19
  s_mov_b32 s19, 400000
L_poll_attn_kernel_a:
  buffer_load_dwordx2 v[134:135], v136, s[92:95], 0 offen sc0 sc1
  s_waitcnt vmcnt(0)
  v_cmp_ne_u64 vcc, v[134:135], v[132:133]
  s_sub_u32 s19, s19, 1
  s_nop 2
  s_cmp_eq_u64 vcc, 0
  s_cbranch_scc1 L_poll_attn_kernel_aok
  s_cmp_lg_u32 s19, 0
  s_cbranch_scc1 L_poll_attn_kernel_a
L_poll_attn_kernel_aok:
  s_mov_b64 exec, -1
  s_mov_b32 s19, 400000
L_poll_attn_kernel:
  buffer_load_dwordx2 v[134:135], v136, s[92:95], 0 offen sc0 sc1
  s_waitcnt vmcnt(0)
  v_cmp_ne_u64 vcc, v[134:135], v[132:133]
  s_sub_u32 s19, s19, 1
  s_nop 2
  s_cmp_eq_u64 vcc, 0
  s_cbranch_scc1 L_poll_attn_kernel_ok
  s_cmp_lg_u32 s19, 0
  s_cbranch_scc1 L_poll_attn_kernel
L_poll_attn_kernel_ok:
L_attn_kernel_nopoll:
  s_barrier
  s_bitcmp1_b32 s16, 0
  s_cbranch_scc1 L_attn_kernel_odd0
  s_add_u32 m0, s18, 0
  s_add_u32 s27, s17, 0
  buffer_load_dwordx4 v20, s[8:11], s27 offen offset:0 lds
  buffer_load_dwordx4 v20, s[8:11], s27 offen offset:1024 lds
  buffer_load_dwordx4 v20, s[8:11], s27 offen offset:2048 lds
  buffer_load_dwordx4 v20, s[8:11], s27 offen offset:3072 lds
  s_waitcnt vmcnt(0)
  s_barrier
  s_add_u32 m0, s18, 4096
  s_add_u32 s27, s17, 4096
  buffer_load_dwordx4 v20, s[8:11], s27 offen offset:0 lds
  buffer_load_dwordx4 v20, s[8:11], s27 offen offset:1024 lds
  buffer_load_dwordx4 v20, s[8:11], s27 offen offset:2048 lds
  buffer_load_dwordx4 v20, s[8:11], s27 offen offset:3072 lds
  s_branch L_attn_kernel_odd1
L_attn_kernel_odd0:
  s_barrier
  s_add_u32 m0, s18, 0
  s_add_u32 s27, s17, 0
  buffer_load_dwordx4 v20, s[8:11], s27 offen offset:0 lds
  buffer_load_dwordx4 v20, s[8:11], s27 offen offset:1024 lds
  buffer_load_dwordx4 v20, s[8:11], s27 offen offset:2048 lds
  buffer_load_dwordx4 v20, s[8:11], s27 offen offset:3072 lds
  s_add_u32 m0, s18, 4096
  s_add_u32 s27, s17, 4096
  buffer_load_dwordx4 v20, s[8:11], s27 offen offset:0 lds
  buffer_load_dwordx4 v20, s[8:11], s27 offen offset:1024 lds
  buffer_load_dwordx4 v20, s[8:11], s27 offen offset:2048 lds
  buffer_load_dwordx4 v20, s[8:11], s27 offen offset:3072 lds
L_attn_kernel_odd1:
  s_add_u32 s18, s18, 32768
  s_add_u32 s17, s17, 16384
  s_mov_b32 m0, s18
  s_add_u32 s18, s18, 32768
  buffer_load_dwordx4 v20, s[8:11], s17 offen offset:0 lds
  buffer_load_dwordx4 v20, s[8:11], s17 offen offset:1024 lds
  buffer_load_dwordx4 v20, s[8:11], s17 offen offset:2048 lds
  buffer_load_dwordx4 v20, s[8:11], s17 offen offset:3072 lds
  s_add_u32 m0, m0, 4096
  s_add_u32 s27, s17, 4096
  buffer_load_dwordx4 v20, s[8:11], s27 offen offset:0 lds
  buffer_load_dwordx4 v20, s[8:11], s27 offen offset:1024 lds
  buffer_load_dwordx4 v20, s[8:11], s27 offen offset:2048 lds
  buffer_load_dwordx4 v20, s[8:11], s27 offen offset:3072 lds
  s_add_u32 s17, s17, 16384
  s_cmp_ge_u32 s18, 98304
  s_cselect_b32 s25, 98304, 0
  s_sub_u32 s18, s18, s25
  s_waitcnt vmcnt(8)
  s_barrier
  s_load_dwordx2 s[60:61], s[0:1], 32
  s_load_dwordx2 s[62:63], s[0:1], 56
  s_lshr_b32 s24, s2, 3
  s_lshl_b32 s24, s24, 5
  s_lshl_b32 s25, s16, 3
  s_add_u32 s24, s24, s25
  s_lshl_b32 s24, s24, 11
  s_and_b32 s25, s2, 1
  s_lshl_b32 s25, s25, 10
  s_add_u32 s24, s24, s25
  v_lshrrev_b32 v4, 7, v1
  v_lshlrev_b32 v4, 11, v4
  v_bfe_u32 v5, v1, 4, 3
  v_lshl_add_u32 v4, v5, 7, v4
  s_bitcmp1_b32 s2, 2
  s_waitcnt lgkmcnt(0)
  s_cselect_b32 s56, s62, s60
  s_cselect_b32 s57, s63, s61
  s_and_b32 s57, s57, 0xffff
  s_mov_b32 s58, 2097152
  s_mov_b32 s59, 0x20000
  s_mov_b32 s74, s24
  v_mov_b32 v156, v4
  s_load_dwordx2 s[68:69], s[0:1], 32
  s_load_dwordx2 s[70:71], s[0:1], 56
  v_lshrrev_b32 v152, 4, v1
  s_lshl_b32 s72, s16, 12
  s_add_u32 s72, s72, 65536
  s_waitcnt lgkmcnt(0)
  s_bitcmp1_b32 s2, 2
  s_cselect_b32 s64, s70, s68
  s_cselect_b32 s65, s71, s69
  s_lshr_b32 s24, s2, 6
  s_and_b32 s24, s24, 3
  s_and_b32 s25, s2, 1
  s_lshl_b32 s25, s25, 2
  s_add_u32 s24, s24, s25
  s_lshl_b32 s24, s24, 8
  s_add_u32 s64, s64, s24
  s_addc_u32 s65, s65, 0
  s_and_b32 s65, s65, 0xffff
  s_sub_u32 s66, 2097152, s24
  s_mov_b32 s67, 0x20000
  v_lshrrev_b32 v4, 4, v152
  s_lshl_b32 s24, s16, 4
  s_add_u32 s24, s24, 0
  v_add_u32 v4, s24, v4
  v_and_b32 v5, 7, v4
  v_lshlrev_b32 v5, 1, v5
  v_and_b32 v6, 15, v152
  v_xor_b32 v5, v5, v6
  v_lshlrev_b32 v5, 4, v5
  v_lshl_add_u32 v148, v4, 11, v5
  v_lshrrev_b32 v4, 4, v152
  s_lshl_b32 s24, s16, 4
  s_add_u32 s24, s24, 4
  v_add_u32 v4, s24, v4
  v_and_b32 v5, 7, v4
  v_lshlrev_b32 v5, 1, v5
  v_and_b32 v6, 15, v152
  v_xor_b32 v5, v5, v6
  v_lshlrev_b32 v5, 4, v5
  v_lshl_add_u32 v149, v4, 11, v5
  v_lshrrev_b32 v4, 4, v152
  s_lshl_b32 s24, s16, 4
  s_add_u32 s24, s24, 8
  v_add_u32 v4, s24, v4
  v_and_b32 v5, 7, v4
  v_lshlrev_b32 v5, 1, v5
  v_and_b32 v6, 15, v152
  v_xor_b32 v5, v5, v6
  v_lshlrev_b32 v5, 4, v5
  v_lshl_add_u32 v150, v4, 11, v5
  v_lshrrev_b32 v4, 4, v152
  s_lshl_b32 s24, s16, 4
  s_add_u32 s24, s24, 12
  v_add_u32 v4, s24, v4
  v_and_b32 v5, 7, v4
  v_lshlrev_b32 v5, 1, v5
  v_and_b32 v6, 15, v152
  v_xor_b32 v5, v5, v6
  v_lshlrev_b32 v5, 4, v5
  v_lshl_add_u32 v151, v4, 11, v5
  s_mov_b32 s19, 6
L_attn_kernel_ldloop:
  s_waitcnt vmcnt(0)
  s_barrier
  s_mov_b32 m0, s18
  s_add_u32 s18, s18, 32768
  buffer_load_dwordx4 v20, s[8:11], s17 offen offset:0 lds
  buffer_load_dwordx4 v20, s[8:11], s17 offen offset:1024 lds
  buffer_load_dwordx4 v20, s[8:11], s17 offen offset:2048 lds
  buffer_load_dwordx4 v20, s[8:11], s17 offen offset:3072 lds
  s_add_u32 m0, m0, 4096
  s_add_u32 s27, s17, 4096
  buffer_load_dwordx4 v20, s[8:11], s27 offen offset:0 lds
  buffer_load_dwordx4 v20, s[8:11], s27 offen offset:1024 lds
  buffer_load_dwordx4 v20, s[8:11], s27 offen offset:2048 lds
  buffer_load_dwordx4 v20, s[8:11], s27 offen offset:3072 lds
  s_add_u32 s17, s17, 16384
  s_cmp_ge_u32 s18, 98304
  s_cselect_b32 s25, 98304, 0
  s_sub_u32 s18, s18, s25
  s_cmp_lg_u32 s19, 2
  s_cbranch_scc1 L_attn_kernel_nowt
  buffer_load_dword v10, v156, s[56:59], s74 offen
L_attn_kernel_nowt:
  s_sub_u32 s19, s19, 1
  s_cmp_lg_u32 s19, 0
  s_cbranch_scc1 L_attn_kernel_ldloop
  s_waitcnt vmcnt(0)
  s_barrier
  s_add_u32 m0, s72, 0
  s_mov_b32 s24, 0
  buffer_load_dwordx4 v148, s[64:67], s24 offen lds
  s_add_u32 m0, m0, 1024
  s_nop 0
  buffer_load_dwordx4 v149, s[64:67], s24 offen lds
  s_add_u32 m0, m0, 1024
  s_nop 0
  buffer_load_dwordx4 v150, s[64:67], s24 offen lds
  s_add_u32 m0, m0, 1024
  s_nop 0
  buffer_load_dwordx4 v151, s[64:67], s24 offen lds
  s_add_u32 m0, s72, 16384
  s_mov_b32 s24, 131072
  buffer_load_dwordx4 v148, s[64:67], s24 offen lds
  s_add_u32 m0, m0, 1024
  s_nop 0
  buffer_load_dwordx4 v149, s[64:67], s24 offen lds
  s_add_u32 m0, m0, 1024
  s_nop 0
  buffer_load_dwordx4 v150, s[64:67], s24 offen lds
  s_add_u32 m0, m0, 1024
  s_nop 0
  buffer_load_dwordx4 v151, s[64:67], s24 offen lds
  s_add_u32 m0, s72, 32768
  s_mov_b32 s24, 262144
  buffer_load_dwordx4 v148, s[64:67], s24 offen lds
  s_add_u32 m0, m0, 1024
  s_nop 0
  buffer_load_dwordx4 v149, s[64:67], s24 offen lds
  s_add_u32 m0, m0, 1024
  s_nop 0
  buffer_load_dwordx4 v150, s[64:67], s24 offen lds
  s_add_u32 m0, m0, 1024
  s_nop 0
  buffer_load_dwordx4 v151, s[64:67], s24 offen lds
  s_add_u32 m0, s72, 49152
  s_mov_b32 s24, 393216
  buffer_load_dwordx4 v148, s[64:67], s24 offen lds
  s_add_u32 m0, m0, 1024
  s_nop 0
  buffer_load_dwordx4 v149, s[64:67], s24 offen lds
  s_add_u32 m0, m0, 1024
  s_nop 0
  buffer_load_dwordx4 v150, s[64:67], s24 offen lds
  s_add_u32 m0, m0, 1024
  s_nop 0
  buffer_load_dwordx4 v151, s[64:67], s24 offen lds
  s_add_u32 m0, s72, 65536
  s_mov_b32 s24, 524288
  buffer_load_dwordx4 v148, s[64:67], s24 offen lds
  s_add_u32 m0, m0, 1024
  s_nop 0
  buffer_load_dwordx4 v149, s[64:67], s24 offen lds
  s_add_u32 m0, m0, 1024
  s_nop 0
  buffer_load_dwordx4 v150, s[64:67], s24 offen lds
  s_add_u32 m0, m0, 1024
  s_nop 0
  buffer_load_dwordx4 v151, s[64:67], s24 offen lds
  s_add_u32 m0, s72, 81920
  s_mov_b32 s24, 655360
  buffer_load_dwordx4 v148, s[64:67], s24 offen lds
  s_add_u32 m0, m0, 1024
  s_nop 0
  buffer_load_dwordx4 v149, s[64:67], s24 offen lds
  s_add_u32 m0, m0, 1024
  s_nop 0
  buffer_load_dwordx4 v150, s[64:67], s24 offen lds
  s_add_u32 m0, m0, 1024
  s_nop 0
  buffer_load_dwordx4 v151, s[64:67], s24 offen lds
  s_barrier
  s_barrier
  v_mov_b32 v5, 32768
  ds_read_b128 v[152:155], v5
  s_waitcnt lgkmcnt(0)
  v_or3_b32 v4, v152, v153, v154
  v_or_b32 v4, v4, v155
  s_nop 1
  v_readfirstlane_b32 s24, v4
  s_nop 3
  s_cmp_eq_u32 s24, 0
  s_cbranch_scc1 L_attn_kernel_end
  s_mov_b32 s19, 8
  s_mov_b32 s17, 0
  s_mov_b32 s18, s20
L_attn_kernel_ldslow:
  s_barrier
  s_mov_b32 m0, s18
  s_nop 0
  buffer_load_dwordx4 v20, s[8:11], s17 offen offset:0 lds
  buffer_load_dwordx4 v20, s[8:11], s17 offen offset:1024 lds
  buffer_load_dwordx4 v20, s[8:11], s17 offen offset:2048 lds
  buffer_load_dwordx4 v20, s[8:11], s17 offen offset:3072 lds
  s_add_u32 m0, m0, 4096
  s_add_u32 s27, s17, 4096
  buffer_load_dwordx4 v20, s[8:11], s27 offen offset:0 lds
  buffer_load_dwordx4 v20, s[8:11], s27 offen offset:1024 lds
  buffer_load_dwordx4 v20, s[8:11], s27 offen offset:2048 lds
  buffer_load_dwordx4 v20, s[8:11], s27 offen offset:3072 lds
  s_add_u32 s17, s17, 16384
  s_waitcnt vmcnt(0)
  s_barrier
  s_sub_u32 s19, s19, 1
  s_cmp_lg_u32 s19, 0
  s_cbranch_scc1 L_attn_kernel_ldslow
  s_barrier
  s_branch L_attn_kernel_end
L_attn_kernel_compute:
  s_lshl_b32 s25, s25, 4
  s_lshl_b32 s27, s16, 2
  s_add_u32 s25, s25, s27
  s_lshl_b32 s20, s26, 6
  s_add_u32 s20, s20, s25
  s_lshl_b32 s20, s20, 11
  s_lshl_b32 s21, s25, 5
  s_add_u32 s21, s21, s26
  s_lshl_b32 s21, s21, 11
  s_mul_i32 s27, s24, 4194304
  s_add_u32 s20, s20, s27
  s_add_u32 s21, s21, s27
  s_add_u32 s21, s21, 17825792
  s_waitcnt lgkmcnt(0)
  s_mov_b32 s12, s4
  s_and_b32 s13, s5, 0xffff
  s_mov_b32 s14, 26214400
  s_mov_b32 s15, 0x20000
  v_mov_b32 v52, 0
  v_mov_b32 v53, 0
  v_mov_b32 v54, 0
  v_mov_b32 v55, 0
  v_mov_b32 v56, 0
  v_mov_b32 v57, 0
  v_mov_b32 v58, 0
  v_mov_b32 v59, 0
  v_mov_b32 v60, 0
  v_mov_b32 v61, 0
  v_mov_b32 v62, 0
  v_mov_b32 v63, 0
  v_mov_b32 v64, 0
  v_mov_b32 v65, 0
  v_mov_b32 v66, 0
  v_mov_b32 v67, 0
  v_mov_b32 v116, 0
  v_mov_b32 v117, 0
  v_mov_b32 v68, 0
  v_mov_b32 v69, 0
  v_mov_b32 v70, 0
  v_mov_b32 v71, 0
  v_mov_b32 v72, 0
  v_mov_b32 v73, 0
  v_mov_b32 v74, 0
  v_mov_b32 v75, 0
  v_mov_b32 v76, 0
  v_mov_b32 v77, 0
  v_mov_b32 v78, 0
  v_mov_b32 v79, 0
  v_mov_b32 v80, 0
  v_mov_b32 v81, 0
  v_mov_b32 v82, 0
  v_mov_b32 v83, 0
  v_mov_b32 v120, 0
  v_mov_b32 v121, 0
  v_mov_b32 v84, 0
  v_mov_b32 v85, 0
  v_mov_b32 v86, 0
  v_mov_b32 v87, 0
  v_mov_b32 v88, 0
  v_mov_b32 v89, 0
  v_mov_b32 v90, 0
  v_mov_b32 v91, 0
  v_mov_b32 v92, 0
  v_mov_b32 v93, 0
  v_mov_b32 v94, 0
  v_mov_b32 v95, 0
  v_mov_b32 v96, 0
  v_mov_b32 v97, 0
  v_mov_b32 v98, 0
  v_mov_b32 v99, 0
  v_mov_b32 v124, 0
  v_mov_b32 v125, 0
  v_mov_b32 v100, 0
  v_mov_b32 v101, 0
  v_mov_b32 v102, 0
  v_mov_b32 v103, 0
  v_mov_b32 v104, 0
  v_mov_b32 v105, 0
  v_mov_b32 v106, 0
  v_mov_b32 v107, 0
  v_mov_b32 v108, 0
  v_mov_b32 v109, 0
  v_mov_b32 v110, 0
  v_mov_b32 v111, 0
  v_mov_b32 v112, 0
  v_mov_b32 v113, 0
  v_mov_b32 v114, 0
  v_mov_b32 v115, 0
  v_mov_b32 v128, 0
  v_mov_b32 v129, 0
  v_mov_b32 v118, 0
  v_mov_b32 v119, 0
  v_mov_b32 v122, 0
  v_mov_b32 v123, 0
  v_mov_b32 v126, 0
  v_mov_b32 v127, 0
  v_mov_b32 v130, 0
  v_mov_b32 v131, 0
  v_mov_b32 v172, 0
  v_mov_b32 v204, 0
  v_mov_b32 v173, 0
  v_mov_b32 v205, 0
  v_mov_b32 v174, 0
  v_mov_b32 v206, 0
  v_mov_b32 v175, 0
  v_mov_b32 v207, 0
  v_mov_b32 v176, 0
  v_mov_b32 v208, 0
  v_mov_b32 v177, 0
  v_mov_b32 v209, 0
  v_mov_b32 v178, 0
  v_mov_b32 v210, 0
  v_mov_b32 v179, 0
  v_mov_b32 v211, 0
  v_lshrrev_b32 v4, 4, v1
  v_and_b32 v5, 2, v4
  v_and_b32 v6, 4, v4
  v_mov_b32 v7, 0x3f803f80
  v_cmp_eq_u32 vcc, 0, v5
  s_nop 1
  v_cndmask_b32 v7, 0, v7, vcc
  v_cmp_eq_u32 vcc, 0, v6
  s_nop 1
  v_cndmask_b32 v16, 0, v7, vcc
  v_cndmask_b32 v17, 0, v7, vcc
  v_cndmask_b32 v18, v7, 0, vcc
  v_cndmask_b32 v19, v7, 0, vcc
  v_and_b32 v5, 1, v4
  v_mov_b32 v6, 0x44444444
  v_mov_b32 v7, 0xeeeeeeee
  v_cmp_eq_u32 vcc, 0, v5
  s_nop 1
  v_cndmask_b32 v8, v7, v6, vcc
  v_mov_b32 v2, v1
  v_add_u32 v3, 32768, v1
  s_mov_b32 s22, 65536
  s_mov_b32 s23, 0
  s_mov_b32 s19, 8
  v_mov_b32 v164, s100
  v_mov_b32 v165, s101
  s_add_u32 s92, s4, 31457280
  s_addc_u32 s93, s5, 0
  s_and_b32 s93, s93, 0xffff
  s_mov_b32 s94, 393216
  s_mov_b32 s95, 0x20000
  s_lshl_b32 s24, s30, 2
  s_add_u32 s24, s24, s16
  s_lshr_b32 s25, s24, 3
  s_lshl_b32 s26, s29, 1
  s_add_u32 s25, s25, s26
  s_and_b32 s24, s24, 7
  s_lshr_b32 s26, s28, 3
  s_lshl_b32 s26, s26, 3
  s_add_u32 s24, s24, s26
  s_lshl_b32 s24, s24, 3
  s_add_u32 s24, s24, s25
  s_mul_i32 s24, s24, 1024
  s_and_b32 s25, s2, 7
  s_lshl_b32 s25, s25, 7
  s_add_u32 s24, s24, s25
  v_mov_b32 v4, s24
  s_mov_b64 exec, 1
  s_mov_b32 s27, 400000
L_qpoll_attn_kernel:
  buffer_load_dwordx2 v[166:167], v4, s[92:95], 0 offen sc0 sc1
  s_waitcnt vmcnt(0)
  v_cmp_ne_u64 vcc, v[166:167], v[164:165]
  s_sub_u32 s27, s27, 1
  s_nop 2
  s_cmp_eq_u64 vcc, 0
  s_cbranch_scc1 L_qpoll_attn_kernel_ok
  s_cmp_lg_u32 s27, 0
  s_cbranch_scc1 L_qpoll_attn_kernel
L_qpoll_attn_kernel_ok:
  s_mov_b64 exec, -1
  buffer_load_dwordx4 v[20:23], v1, s[12:15], s20 offen offset:0
  buffer_load_dwordx4 v[24:27], v1, s[12:15], s20 offen offset:1024
  buffer_load_dwordx4 v[28:31], v1, s[12:15], s20 offen offset:2048
  buffer_load_dwordx4 v[32:35], v1, s[12:15], s20 offen offset:3072
  s_add_u32 s20, s20, 4096
  buffer_load_dwordx4 v[36:39], v1, s[12:15], s20 offen offset:0
  buffer_load_dwordx4 v[40:43], v1, s[12:15], s20 offen offset:1024
  buffer_load_dwordx4 v[44:47], v1, s[12:15], s20 offen offset:2048
  buffer_load_dwordx4 v[48:51], v1, s[12:15], s20 offen offset:3072
  s_barrier
  s_waitcnt vmcnt(0)
  s_barrier
  ds_read_b128 v[180:183], v2 offset:0
  ds_read_b128 v[184:187], v2 offset:1024
  ds_read_b128 v[196:199], v2 offset:16384
  ds_read_b128 v[200:203], v2 offset:17408
  s_waitcnt lgkmcnt(0)
  v_mfma_f32_32x32x16_bf16 v[132:147], v[180:183], v[20:23], 0
  v_mfma_f32_32x32x16_bf16 v[132:147], v[184:187], v[24:27], v[132:147]
  s_nop 7
  s_nop 3
  .p2align 6
L_attn_kernel_loop:
  v_mfma_f32_32x32x16_bf16 v[148:163], v[180:183], v[28:31], 0
  v_exp_f32 v132, v132
  v_exp_f32 v133, v133
  v_exp_f32 v134, v134
  v_mfma_f32_32x32x16_bf16 v[100:115], v[204:207], v[172:175], v[100:115]
  v_exp_f32 v135, v135
  v_exp_f32 v136, v136
  v_exp_f32 v137, v137
  v_mfma_f32_32x32x16_bf16 v[148:163], v[184:187], v[32:35], v[148:163]
  v_exp_f32 v138, v138
  v_exp_f32 v139, v139
  v_cvt_pk_bf16_f32 v164, v132, v133
  v_cvt_pk_bf16_f32 v165, v134, v135
  v_mfma_f32_32x32x16_bf16 v[100:115], v[208:211], v[176:179], v[100:115]
  v_exp_f32 v140, v140
  v_exp_f32 v141, v141
  v_cvt_pk_bf16_f32 v166, v136, v137
  v_cvt_pk_bf16_f32 v167, v138, v139
  v_smfmac_f32_16x16x64_bf16 v[128:131], v[16:19], v[172:179], v8
  ds_read_b128 v[188:191], v2 offset:2048
  v_exp_f32 v142, v142
  v_exp_f32 v143, v143
  v_cvt_pk_bf16_f32 v168, v140, v141
  v_exp_f32 v144, v144
  v_exp_f32 v145, v145
  v_cvt_pk_bf16_f32 v169, v142, v143
  v_exp_f32 v146, v146
  v_exp_f32 v147, v147
  v_cvt_pk_bf16_f32 v170, v144, v145
  v_cvt_pk_bf16_f32 v171, v146, v147
  v_mfma_f32_32x32x16_bf16 v[132:147], v[180:183], v[36:39], 0
  v_exp_f32 v148, v148
  v_exp_f32 v149, v149
  v_exp_f32 v150, v150
  v_mfma_f32_32x32x16_bf16 v[52:67], v[196:199], v[164:167], v[52:67]
  v_exp_f32 v151, v151
  v_exp_f32 v152, v152
  v_exp_f32 v153, v153
  v_mfma_f32_32x32x16_bf16 v[132:147], v[184:187], v[40:43], v[132:147]
  v_exp_f32 v154, v154
  v_exp_f32 v155, v155
  v_cvt_pk_bf16_f32 v172, v148, v149
  v_cvt_pk_bf16_f32 v173, v150, v151
  v_mfma_f32_32x32x16_bf16 v[52:67], v[200:203], v[168:171], v[52:67]
  v_exp_f32 v156, v156
  v_exp_f32 v157, v157
  v_cvt_pk_bf16_f32 v174, v152, v153
  v_cvt_pk_bf16_f32 v175, v154, v155
  v_smfmac_f32_16x16x64_bf16 v[116:119], v[16:19], v[164:171], v8
  ds_read_b128 v[192:195], v2 offset:3072
  v_exp_f32 v158, v158
  v_exp_f32 v159, v159
  v_cvt_pk_bf16_f32 v176, v156, v157
  v_exp_f32 v160, v160
  v_exp_f32 v161, v161
  v_cvt_pk_bf16_f32 v177, v158, v159
  v_exp_f32 v162, v162
  v_exp_f32 v163, v163
  v_cvt_pk_bf16_f32 v178, v160, v161
  v_cvt_pk_bf16_f32 v179, v162, v163
  v_mfma_f32_32x32x16_bf16 v[148:163], v[180:183], v[44:47], 0
  v_exp_f32 v132, v132
  v_exp_f32 v133, v133
  v_exp_f32 v134, v134
  v_mfma_f32_32x32x16_bf16 v[68:83], v[196:199], v[172:175], v[68:83]
  v_exp_f32 v135, v135
  v_exp_f32 v136, v136
  v_exp_f32 v137, v137
  v_mfma_f32_32x32x16_bf16 v[148:163], v[184:187], v[48:51], v[148:163]
  v_exp_f32 v138, v138
  v_exp_f32 v139, v139
  v_cvt_pk_bf16_f32 v164, v132, v133
  v_cvt_pk_bf16_f32 v165, v134, v135
  v_mfma_f32_32x32x16_bf16 v[68:83], v[200:203], v[176:179], v[68:83]
  v_exp_f32 v140, v140
  v_exp_f32 v141, v141
  v_cvt_pk_bf16_f32 v166, v136, v137
  v_cvt_pk_bf16_f32 v167, v138, v139
  v_smfmac_f32_16x16x64_bf16 v[120:123], v[16:19], v[172:179], v8
  ds_read_b128 v[204:207], v2 offset:18432
  ds_read_b128 v[208:211], v2 offset:19456
  v_exp_f32 v142, v142
  v_exp_f32 v143, v143
  v_cvt_pk_bf16_f32 v168, v140, v141
  v_exp_f32 v144, v144
  v_exp_f32 v145, v145
  v_cvt_pk_bf16_f32 v169, v142, v143
  v_exp_f32 v146, v146
  v_exp_f32 v147, v147
  v_cvt_pk_bf16_f32 v170, v144, v145
  v_cvt_pk_bf16_f32 v171, v146, v147
  s_waitcnt lgkmcnt(0)
  v_mfma_f32_32x32x16_bf16 v[132:147], v[188:191], v[20:23], 0
  v_exp_f32 v148, v148
  v_exp_f32 v149, v149
  s_cmp_eq_u32 s19, 8
  v_exp_f32 v150, v150
  v_mfma_f32_32x32x16_bf16 v[84:99], v[196:199], v[164:167], v[84:99]
  v_exp_f32 v151, v151
  v_exp_f32 v152, v152
  v_exp_f32 v153, v153
  v_mfma_f32_32x32x16_bf16 v[132:147], v[192:195], v[24:27], v[132:147]
  v_exp_f32 v154, v154
  v_exp_f32 v155, v155
  v_cvt_pk_bf16_f32 v172, v148, v149
  v_cvt_pk_bf16_f32 v173, v150, v151
  v_mfma_f32_32x32x16_bf16 v[84:99], v[200:203], v[168:171], v[84:99]
  v_exp_f32 v156, v156
  v_exp_f32 v157, v157
  v_cvt_pk_bf16_f32 v174, v152, v153
  v_cvt_pk_bf16_f32 v175, v154, v155
  v_smfmac_f32_16x16x64_bf16 v[124:127], v[16:19], v[164:171], v8
  v_exp_f32 v158, v158
  v_exp_f32 v159, v159
  v_cvt_pk_bf16_f32 v176, v156, v157
  v_exp_f32 v160, v160
  v_exp_f32 v161, v161
  v_cvt_pk_bf16_f32 v177, v158, v159
  v_exp_f32 v162, v162
  v_exp_f32 v163, v163
  v_cvt_pk_bf16_f32 v178, v160, v161
  v_cvt_pk_bf16_f32 v179, v162, v163
  s_cbranch_scc1 L_attn_kernel_bar1
L_attn_kernel_bar1r:
  v_mfma_f32_32x32x16_bf16 v[148:163], v[188:191], v[28:31], 0
  v_exp_f32 v132, v132
  v_exp_f32 v133, v133
  v_exp_f32 v134, v134
  v_mfma_f32_32x32x16_bf16 v[100:115], v[196:199], v[172:175], v[100:115]
  v_exp_f32 v135, v135
  v_exp_f32 v136, v136
  v_exp_f32 v137, v137
  v_mfma_f32_32x32x16_bf16 v[148:163], v[192:195], v[32:35], v[148:163]
  v_exp_f32 v138, v138
  v_exp_f32 v139, v139
  v_cvt_pk_bf16_f32 v164, v132, v133
  v_cvt_pk_bf16_f32 v165, v134, v135
  v_mfma_f32_32x32x16_bf16 v[100:115], v[200:203], v[176:179], v[100:115]
  v_exp_f32 v140, v140
  v_exp_f32 v141, v141
  v_cvt_pk_bf16_f32 v166, v136, v137
  v_cvt_pk_bf16_f32 v167, v138, v139
  v_smfmac_f32_16x16x64_bf16 v[128:131], v[16:19], v[172:179], v8
  ds_read_b128 v[180:183], v2 offset:4096
  v_exp_f32 v142, v142
  v_exp_f32 v143, v143
  v_cvt_pk_bf16_f32 v168, v140, v141
  v_exp_f32 v144, v144
  v_exp_f32 v145, v145
  v_cvt_pk_bf16_f32 v169, v142, v143
  v_exp_f32 v146, v146
  v_exp_f32 v147, v147
  v_cvt_pk_bf16_f32 v170, v144, v145
  v_cvt_pk_bf16_f32 v171, v146, v147
  v_mfma_f32_32x32x16_bf16 v[132:147], v[188:191], v[36:39], 0
  v_exp_f32 v148, v148
  v_exp_f32 v149, v149
  v_exp_f32 v150, v150
  v_mfma_f32_32x32x16_bf16 v[52:67], v[204:207], v[164:167], v[52:67]
  v_exp_f32 v151, v151
  v_exp_f32 v152, v152
  v_exp_f32 v153, v153
  v_mfma_f32_32x32x16_bf16 v[132:147], v[192:195], v[40:43], v[132:147]
  v_exp_f32 v154, v154
  v_exp_f32 v155, v155
  v_cvt_pk_bf16_f32 v172, v148, v149
  v_cvt_pk_bf16_f32 v173, v150, v151
  v_mfma_f32_32x32x16_bf16 v[52:67], v[208:211], v[168:171], v[52:67]
  v_exp_f32 v156, v156
  v_exp_f32 v157, v157
  v_cvt_pk_bf16_f32 v174, v152, v153
  v_cvt_pk_bf16_f32 v175, v154, v155
  v_smfmac_f32_16x16x64_bf16 v[116:119], v[16:19], v[164:171], v8
  ds_read_b128 v[184:187], v2 offset:5120
  v_exp_f32 v158, v158
  v_exp_f32 v159, v159
  v_cvt_pk_bf16_f32 v176, v156, v157
  v_exp_f32 v160, v160
  v_exp_f32 v161, v161
  v_cvt_pk_bf16_f32 v177, v158, v159
  v_exp_f32 v162, v162
  v_exp_f32 v163, v163
  v_cvt_pk_bf16_f32 v178, v160, v161
  v_cvt_pk_bf16_f32 v179, v162, v163
  v_mfma_f32_32x32x16_bf16 v[148:163], v[188:191], v[44:47], 0
  v_exp_f32 v132, v132
  v_exp_f32 v133, v133
  v_exp_f32 v134, v134
  v_mfma_f32_32x32x16_bf16 v[68:83], v[204:207], v[172:175], v[68:83]
  v_exp_f32 v135, v135
  v_exp_f32 v136, v136
  v_exp_f32 v137, v137
  v_mfma_f32_32x32x16_bf16 v[148:163], v[192:195], v[48:51], v[148:163]
  v_exp_f32 v138, v138
  v_exp_f32 v139, v139
  v_cvt_pk_bf16_f32 v164, v132, v133
  v_cvt_pk_bf16_f32 v165, v134, v135
  v_mfma_f32_32x32x16_bf16 v[68:83], v[208:211], v[176:179], v[68:83]
  v_exp_f32 v140, v140
  v_exp_f32 v141, v141
  v_cvt_pk_bf16_f32 v166, v136, v137
  v_cvt_pk_bf16_f32 v167, v138, v139
  v_smfmac_f32_16x16x64_bf16 v[120:123], v[16:19], v[172:179], v8
  ds_read_b128 v[196:199], v2 offset:20480
  ds_read_b128 v[200:203], v2 offset:21504
  v_exp_f32 v142, v142
  v_exp_f32 v143, v143
  v_cvt_pk_bf16_f32 v168, v140, v141
  v_exp_f32 v144, v144
  v_exp_f32 v145, v145
  v_cvt_pk_bf16_f32 v169, v142, v143
  v_exp_f32 v146, v146
  v_exp_f32 v147, v147
  v_cvt_pk_bf16_f32 v170, v144, v145
  v_cvt_pk_bf16_f32 v171, v146, v147
  s_waitcnt lgkmcnt(0)
  v_mfma_f32_32x32x16_bf16 v[132:147], v[180:183], v[20:23], 0
  v_exp_f32 v148, v148
  v_exp_f32 v149, v149
  v_exp_f32 v150, v150
  v_mfma_f32_32x32x16_bf16 v[84:99], v[204:207], v[164:167], v[84:99]
  v_exp_f32 v151, v151
  v_exp_f32 v152, v152
  v_exp_f32 v153, v153
  v_mfma_f32_32x32x16_bf16 v[132:147], v[184:187], v[24:27], v[132:147]
  v_exp_f32 v154, v154
  v_exp_f32 v155, v155
  v_cvt_pk_bf16_f32 v172, v148, v149
  v_cvt_pk_bf16_f32 v173, v150, v151
  v_mfma_f32_32x32x16_bf16 v[84:99], v[208:211], v[168:171], v[84:99]
  v_exp_f32 v156, v156
  v_exp_f32 v157, v157
  v_cvt_pk_bf16_f32 v174, v152, v153
  v_cvt_pk_bf16_f32 v175, v154, v155
  v_smfmac_f32_16x16x64_bf16 v[124:127], v[16:19], v[164:171], v8
  v_exp_f32 v158, v158
  v_exp_f32 v159, v159
  v_cvt_pk_bf16_f32 v176, v156, v157
  v_exp_f32 v160, v160
  v_exp_f32 v161, v161
  v_cvt_pk_bf16_f32 v177, v158, v159
  v_exp_f32 v162, v162
  v_exp_f32 v163, v163
  v_cvt_pk_bf16_f32 v178, v160, v161
  v_cvt_pk_bf16_f32 v179, v162, v163
  v_mfma_f32_32x32x16_bf16 v[148:163], v[180:183], v[28:31], 0
  v_exp_f32 v132, v132
  v_exp_f32 v133, v133
  v_exp_f32 v134, v134
  v_mfma_f32_32x32x16_bf16 v[100:115], v[204:207], v[172:175], v[100:115]
  v_exp_f32 v135, v135
  v_exp_f32 v136, v136
  v_exp_f32 v137, v137
  v_mfma_f32_32x32x16_bf16 v[148:163], v[184:187], v[32:35], v[148:163]
  v_exp_f32 v138, v138
  v_exp_f32 v139, v139
  v_cvt_pk_bf16_f32 v164, v132, v133
  v_cvt_pk_bf16_f32 v165, v134, v135
  v_mfma_f32_32x32x16_bf16 v[100:115], v[208:211], v[176:179], v[100:115]
  v_exp_f32 v140, v140
  v_exp_f32 v141, v141
  v_cvt_pk_bf16_f32 v166, v136, v137
  v_cvt_pk_bf16_f32 v167, v138, v139
  v_smfmac_f32_16x16x64_bf16 v[128:131], v[16:19], v[172:179], v8
  ds_read_b128 v[188:191], v2 offset:6144
  v_exp_f32 v142, v142
  v_exp_f32 v143, v143
  v_cvt_pk_bf16_f32 v168, v140, v141
  v_exp_f32 v144, v144
  v_exp_f32 v145, v145
  v_cvt_pk_bf16_f32 v169, v142, v143
  v_exp_f32 v146, v146
  v_exp_f32 v147, v147
  v_cvt_pk_bf16_f32 v170, v144, v145
  v_cvt_pk_bf16_f32 v171, v146, v147
  v_mfma_f32_32x32x16_bf16 v[132:147], v[180:183], v[36:39], 0
  v_exp_f32 v148, v148
  v_exp_f32 v149, v149
  v_exp_f32 v150, v150
  v_mfma_f32_32x32x16_bf16 v[52:67], v[196:199], v[164:167], v[52:67]
  v_exp_f32 v151, v151
  v_exp_f32 v152, v152
  v_exp_f32 v153, v153
  v_mfma_f32_32x32x16_bf16 v[132:147], v[184:187], v[40:43], v[132:147]
  v_exp_f32 v154, v154
  v_exp_f32 v155, v155
  v_cvt_pk_bf16_f32 v172, v148, v149
  v_cvt_pk_bf16_f32 v173, v150, v151
  v_mfma_f32_32x32x16_bf16 v[52:67], v[200:203], v[168:171], v[52:67]
  v_exp_f32 v156, v156
  v_exp_f32 v157, v157
  v_cvt_pk_bf16_f32 v174, v152, v153
  v_cvt_pk_bf16_f32 v175, v154, v155
  v_smfmac_f32_16x16x64_bf16 v[116:119], v[16:19], v[164:171], v8
  ds_read_b128 v[192:195], v2 offset:7168
  v_exp_f32 v158, v158
  v_exp_f32 v159, v159
  v_cvt_pk_bf16_f32 v176, v156, v157
  v_exp_f32 v160, v160
  v_exp_f32 v161, v161
  v_cvt_pk_bf16_f32 v177, v158, v159
  v_exp_f32 v162, v162
  v_exp_f32 v163, v163
  v_cvt_pk_bf16_f32 v178, v160, v161
  v_cvt_pk_bf16_f32 v179, v162, v163
  v_mfma_f32_32x32x16_bf16 v[148:163], v[180:183], v[44:47], 0
  v_exp_f32 v132, v132
  v_exp_f32 v133, v133
  v_exp_f32 v134, v134
  v_mfma_f32_32x32x16_bf16 v[68:83], v[196:199], v[172:175], v[68:83]
  v_exp_f32 v135, v135
  v_exp_f32 v136, v136
  v_exp_f32 v137, v137
  v_mfma_f32_32x32x16_bf16 v[148:163], v[184:187], v[48:51], v[148:163]
  v_exp_f32 v138, v138
  v_exp_f32 v139, v139
  v_cvt_pk_bf16_f32 v164, v132, v133
  v_cvt_pk_bf16_f32 v165, v134, v135
  v_mfma_f32_32x32x16_bf16 v[68:83], v[200:203], v[176:179], v[68:83]
  v_exp_f32 v140, v140
  v_exp_f32 v141, v141
  v_cvt_pk_bf16_f32 v166, v136, v137
  v_cvt_pk_bf16_f32 v167, v138, v139
  v_smfmac_f32_16x16x64_bf16 v[120:123], v[16:19], v[172:179], v8
  ds_read_b128 v[204:207], v2 offset:22528
  ds_read_b128 v[208:211], v2 offset:23552
  v_exp_f32 v142, v142
  v_exp_f32 v143, v143
  v_cvt_pk_bf16_f32 v168, v140, v141
  v_exp_f32 v144, v144
  v_exp_f32 v145, v145
  v_cvt_pk_bf16_f32 v169, v142, v143
  v_exp_f32 v146, v146
  v_exp_f32 v147, v147
  v_cvt_pk_bf16_f32 v170, v144, v145
  v_cvt_pk_bf16_f32 v171, v146, v147
  s_waitcnt lgkmcnt(0)
  v_mfma_f32_32x32x16_bf16 v[132:147], v[188:191], v[20:23], 0
  v_exp_f32 v148, v148
  v_exp_f32 v149, v149
  v_exp_f32 v150, v150
  v_mfma_f32_32x32x16_bf16 v[84:99], v[196:199], v[164:167], v[84:99]
  v_exp_f32 v151, v151
  v_exp_f32 v152, v152
  v_exp_f32 v153, v153
  v_mfma_f32_32x32x16_bf16 v[132:147], v[192:195], v[24:27], v[132:147]
  v_exp_f32 v154, v154
  v_exp_f32 v155, v155
  v_cvt_pk_bf16_f32 v172, v148, v149
  v_cvt_pk_bf16_f32 v173, v150, v151
  v_mfma_f32_32x32x16_bf16 v[84:99], v[200:203], v[168:171], v[84:99]
  v_exp_f32 v156, v156
  v_exp_f32 v157, v157
  v_cvt_pk_bf16_f32 v174, v152, v153
  v_cvt_pk_bf16_f32 v175, v154, v155
  v_smfmac_f32_16x16x64_bf16 v[124:127], v[16:19], v[164:171], v8
  v_exp_f32 v158, v158
  v_exp_f32 v159, v159
  v_cvt_pk_bf16_f32 v176, v156, v157
  v_exp_f32 v160, v160
  v_exp_f32 v161, v161
  v_cvt_pk_bf16_f32 v177, v158, v159
  v_exp_f32 v162, v162
  v_exp_f32 v163, v163
  v_cvt_pk_bf16_f32 v178, v160, v161
  v_cvt_pk_bf16_f32 v179, v162, v163
  v_mfma_f32_32x32x16_bf16 v[148:163], v[188:191], v[28:31], 0
  v_exp_f32 v132, v132
  v_exp_f32 v133, v133
  v_exp_f32 v134, v134
  v_mfma_f32_32x32x16_bf16 v[100:115], v[196:199], v[172:175], v[100:115]
  v_exp_f32 v135, v135
  v_exp_f32 v136, v136
  v_exp_f32 v137, v137
  v_mfma_f32_32x32x16_bf16 v[148:163], v[192:195], v[32:35], v[148:163]
  v_exp_f32 v138, v138
  v_exp_f32 v139, v139
  v_cvt_pk_bf16_f32 v164, v132, v133
  v_cvt_pk_bf16_f32 v165, v134, v135
  v_mfma_f32_32x32x16_bf16 v[100:115], v[200:203], v[176:179], v[100:115]
  v_exp_f32 v140, v140
  v_exp_f32 v141, v141
  v_cvt_pk_bf16_f32 v166, v136, v137
  v_cvt_pk_bf16_f32 v167, v138, v139
  v_smfmac_f32_16x16x64_bf16 v[128:131], v[16:19], v[172:179], v8
  ds_read_b128 v[180:183], v2 offset:8192
  v_exp_f32 v142, v142
  v_exp_f32 v143, v143
  v_cvt_pk_bf16_f32 v168, v140, v141
  v_exp_f32 v144, v144
  v_exp_f32 v145, v145
  v_cvt_pk_bf16_f32 v169, v142, v143
  v_exp_f32 v146, v146
  v_exp_f32 v147, v147
  v_cvt_pk_bf16_f32 v170, v144, v145
  v_cvt_pk_bf16_f32 v171, v146, v147
  v_mfma_f32_32x32x16_bf16 v[132:147], v[188:191], v[36:39], 0
  v_exp_f32 v148, v148
  v_exp_f32 v149, v149
  v_exp_f32 v150, v150
  v_mfma_f32_32x32x16_bf16 v[52:67], v[204:207], v[164:167], v[52:67]
  v_exp_f32 v151, v151
  v_exp_f32 v152, v152
  v_exp_f32 v153, v153
  v_mfma_f32_32x32x16_bf16 v[132:147], v[192:195], v[40:43], v[132:147]
  v_exp_f32 v154, v154
  v_exp_f32 v155, v155
  v_cvt_pk_bf16_f32 v172, v148, v149
  v_cvt_pk_bf16_f32 v173, v150, v151
  v_mfma_f32_32x32x16_bf16 v[52:67], v[208:211], v[168:171], v[52:67]
  v_exp_f32 v156, v156
  v_exp_f32 v157, v157
  v_cvt_pk_bf16_f32 v174, v152, v153
  v_cvt_pk_bf16_f32 v175, v154, v155
  v_smfmac_f32_16x16x64_bf16 v[116:119], v[16:19], v[164:171], v8
  ds_read_b128 v[184:187], v2 offset:9216
  v_exp_f32 v158, v158
  v_exp_f32 v159, v159
  v_cvt_pk_bf16_f32 v176, v156, v157
  v_exp_f32 v160, v160
  v_exp_f32 v161, v161
  v_cvt_pk_bf16_f32 v177, v158, v159
  v_exp_f32 v162, v162
  v_exp_f32 v163, v163
  v_cvt_pk_bf16_f32 v178, v160, v161
  v_cvt_pk_bf16_f32 v179, v162, v163
  v_mfma_f32_32x32x16_bf16 v[148:163], v[188:191], v[44:47], 0
  v_exp_f32 v132, v132
  v_exp_f32 v133, v133
  v_exp_f32 v134, v134
  v_mfma_f32_32x32x16_bf16 v[68:83], v[204:207], v[172:175], v[68:83]
  v_exp_f32 v135, v135
  v_exp_f32 v136, v136
  v_exp_f32 v137, v137
  v_mfma_f32_32x32x16_bf16 v[148:163], v[192:195], v[48:51], v[148:163]
  v_exp_f32 v138, v138
  v_exp_f32 v139, v139
  v_cvt_pk_bf16_f32 v164, v132, v133
  v_cvt_pk_bf16_f32 v165, v134, v135
  v_mfma_f32_32x32x16_bf16 v[68:83], v[208:211], v[176:179], v[68:83]
  v_exp_f32 v140, v140
  v_exp_f32 v141, v141
  v_cvt_pk_bf16_f32 v166, v136, v137
  v_cvt_pk_bf16_f32 v167, v138, v139
  v_smfmac_f32_16x16x64_bf16 v[120:123], v[16:19], v[172:179], v8
  ds_read_b128 v[196:199], v2 offset:24576
  ds_read_b128 v[200:203], v2 offset:25600
  v_exp_f32 v142, v142
  v_exp_f32 v143, v143
  v_cvt_pk_bf16_f32 v168, v140, v141
  v_exp_f32 v144, v144
  v_exp_f32 v145, v145
  v_cvt_pk_bf16_f32 v169, v142, v143
  v_exp_f32 v146, v146
  v_exp_f32 v147, v147
  v_cvt_pk_bf16_f32 v170, v144, v145
  v_cvt_pk_bf16_f32 v171, v146, v147
  s_waitcnt lgkmcnt(0)
  v_mfma_f32_32x32x16_bf16 v[132:147], v[180:183], v[20:23], 0
  v_exp_f32 v148, v148
  v_exp_f32 v149, v149
  v_exp_f32 v150, v150
  v_mfma_f32_32x32x16_bf16 v[84:99], v[204:207], v[164:167], v[84:99]
  v_exp_f32 v151, v151
  v_exp_f32 v152, v152
  v_exp_f32 v153, v153
  v_mfma_f32_32x32x16_bf16 v[132:147], v[184:187], v[24:27], v[132:147]
  v_exp_f32 v154, v154
  v_exp_f32 v155, v155
  v_cvt_pk_bf16_f32 v172, v148, v149
  v_cvt_pk_bf16_f32 v173, v150, v151
  v_mfma_f32_32x32x16_bf16 v[84:99], v[208:211], v[168:171], v[84:99]
  v_exp_f32 v156, v156
  v_exp_f32 v157, v157
  v_cvt_pk_bf16_f32 v174, v152, v153
  v_cvt_pk_bf16_f32 v175, v154, v155
  v_smfmac_f32_16x16x64_bf16 v[124:127], v[16:19], v[164:171], v8
  v_exp_f32 v158, v158
  v_exp_f32 v159, v159
  v_cvt_pk_bf16_f32 v176, v156, v157
  v_exp_f32 v160, v160
  v_exp_f32 v161, v161
  v_cvt_pk_bf16_f32 v177, v158, v159
  v_exp_f32 v162, v162
  v_exp_f32 v163, v163
  v_cvt_pk_bf16_f32 v178, v160, v161
  v_cvt_pk_bf16_f32 v179, v162, v163
  v_mfma_f32_32x32x16_bf16 v[148:163], v[180:183], v[28:31], 0
  v_exp_f32 v132, v132
  v_exp_f32 v133, v133
  v_exp_f32 v134, v134
  v_mfma_f32_32x32x16_bf16 v[100:115], v[204:207], v[172:175], v[100:115]
  v_exp_f32 v135, v135
  v_exp_f32 v136, v136
  v_exp_f32 v137, v137
  v_mfma_f32_32x32x16_bf16 v[148:163], v[184:187], v[32:35], v[148:163]
  v_exp_f32 v138, v138
  v_exp_f32 v139, v139
  v_cvt_pk_bf16_f32 v164, v132, v133
  v_cvt_pk_bf16_f32 v165, v134, v135
  v_mfma_f32_32x32x16_bf16 v[100:115], v[208:211], v[176:179], v[100:115]
  v_exp_f32 v140, v140
  v_exp_f32 v141, v141
  v_cvt_pk_bf16_f32 v166, v136, v137
  v_cvt_pk_bf16_f32 v167, v138, v139
  v_smfmac_f32_16x16x64_bf16 v[128:131], v[16:19], v[172:179], v8
  ds_read_b128 v[188:191], v2 offset:10240
  v_exp_f32 v142, v142
  v_exp_f32 v143, v143
  v_cvt_pk_bf16_f32 v168, v140, v141
  v_exp_f32 v144, v144
  v_exp_f32 v145, v145
  v_cvt_pk_bf16_f32 v169, v142, v143
  v_exp_f32 v146, v146
  v_exp_f32 v147, v147
  v_cvt_pk_bf16_f32 v170, v144, v145
  v_cvt_pk_bf16_f32 v171, v146, v147
  v_mfma_f32_32x32x16_bf16 v[132:147], v[180:183], v[36:39], 0
  v_exp_f32 v148, v148
  v_exp_f32 v149, v149
  v_exp_f32 v150, v150
  v_mfma_f32_32x32x16_bf16 v[52:67], v[196:199], v[164:167], v[52:67]
  v_exp_f32 v151, v151
  v_exp_f32 v152, v152
  v_exp_f32 v153, v153
  v_mfma_f32_32x32x16_bf16 v[132:147], v[184:187], v[40:43], v[132:147]
  v_exp_f32 v154, v154
  v_exp_f32 v155, v155
  v_cvt_pk_bf16_f32 v172, v148, v149
  v_cvt_pk_bf16_f32 v173, v150, v151
  v_mfma_f32_32x32x16_bf16 v[52:67], v[200:203], v[168:171], v[52:67]
  v_exp_f32 v156, v156
  v_exp_f32 v157, v157
  v_cvt_pk_bf16_f32 v174, v152, v153
  v_cvt_pk_bf16_f32 v175, v154, v155
  v_smfmac_f32_16x16x64_bf16 v[116:119], v[16:19], v[164:171], v8
  ds_read_b128 v[192:195], v2 offset:11264
  v_exp_f32 v158, v158
  v_exp_f32 v159, v159
  v_cvt_pk_bf16_f32 v176, v156, v157
  v_exp_f32 v160, v160
  v_exp_f32 v161, v161
  v_cvt_pk_bf16_f32 v177, v158, v159
  v_exp_f32 v162, v162
  v_exp_f32 v163, v163
  v_cvt_pk_bf16_f32 v178, v160, v161
  v_cvt_pk_bf16_f32 v179, v162, v163
  v_mfma_f32_32x32x16_bf16 v[148:163], v[180:183], v[44:47], 0
  v_exp_f32 v132, v132
  v_exp_f32 v133, v133
  v_exp_f32 v134, v134
  v_mfma_f32_32x32x16_bf16 v[68:83], v[196:199], v[172:175], v[68:83]
  v_exp_f32 v135, v135
  v_exp_f32 v136, v136
  v_exp_f32 v137, v137
  v_mfma_f32_32x32x16_bf16 v[148:163], v[184:187], v[48:51], v[148:163]
  v_exp_f32 v138, v138
  v_exp_f32 v139, v139
  v_cvt_pk_bf16_f32 v164, v132, v133
  v_cvt_pk_bf16_f32 v165, v134, v135
  v_mfma_f32_32x32x16_bf16 v[68:83], v[200:203], v[176:179], v[68:83]
  v_exp_f32 v140, v140
  v_exp_f32 v141, v141
  v_cvt_pk_bf16_f32 v166, v136, v137
  v_cvt_pk_bf16_f32 v167, v138, v139
  v_smfmac_f32_16x16x64_bf16 v[120:123], v[16:19], v[172:179], v8
  ds_read_b128 v[204:207], v2 offset:26624
  ds_read_b128 v[208:211], v2 offset:27648
  v_exp_f32 v142, v142
  v_exp_f32 v143, v143
  v_cvt_pk_bf16_f32 v168, v140, v141
  v_exp_f32 v144, v144
  v_exp_f32 v145, v145
  v_cvt_pk_bf16_f32 v169, v142, v143
  v_exp_f32 v146, v146
  v_exp_f32 v147, v147
  v_cvt_pk_bf16_f32 v170, v144, v145
  v_cvt_pk_bf16_f32 v171, v146, v147
  s_waitcnt lgkmcnt(0)
  v_mfma_f32_32x32x16_bf16 v[132:147], v[188:191], v[20:23], 0
  v_exp_f32 v148, v148
  v_exp_f32 v149, v149
  v_exp_f32 v150, v150
  v_mfma_f32_32x32x16_bf16 v[84:99], v[196:199], v[164:167], v[84:99]
  v_exp_f32 v151, v151
  v_exp_f32 v152, v152
  v_exp_f32 v153, v153
  v_mfma_f32_32x32x16_bf16 v[132:147], v[192:195], v[24:27], v[132:147]
  v_exp_f32 v154, v154
  v_exp_f32 v155, v155
  v_cvt_pk_bf16_f32 v172, v148, v149
  v_cvt_pk_bf16_f32 v173, v150, v151
  v_mfma_f32_32x32x16_bf16 v[84:99], v[200:203], v[168:171], v[84:99]
  v_exp_f32 v156, v156
  v_exp_f32 v157, v157
  v_cvt_pk_bf16_f32 v174, v152, v153
  v_cvt_pk_bf16_f32 v175, v154, v155
  v_smfmac_f32_16x16x64_bf16 v[124:127], v[16:19], v[164:171], v8
  v_exp_f32 v158, v158
  v_exp_f32 v159, v159
  v_cvt_pk_bf16_f32 v176, v156, v157
  v_exp_f32 v160, v160
  v_exp_f32 v161, v161
  v_cvt_pk_bf16_f32 v177, v158, v159
  v_exp_f32 v162, v162
  v_exp_f32 v163, v163
  v_cvt_pk_bf16_f32 v178, v160, v161
  v_cvt_pk_bf16_f32 v179, v162, v163
  v_mfma_f32_32x32x16_bf16 v[148:163], v[188:191], v[28:31], 0
  v_exp_f32 v132, v132
  v_exp_f32 v133, v133
  v_exp_f32 v134, v134
  v_mfma_f32_32x32x16_bf16 v[100:115], v[196:199], v[172:175], v[100:115]
  v_exp_f32 v135, v135
  v_exp_f32 v136, v136
  v_exp_f32 v137, v137
  v_mfma_f32_32x32x16_bf16 v[148:163], v[192:195], v[32:35], v[148:163]
  v_exp_f32 v138, v138
  v_exp_f32 v139, v139
  v_cvt_pk_bf16_f32 v164, v132, v133
  v_cvt_pk_bf16_f32 v165, v134, v135
  v_mfma_f32_32x32x16_bf16 v[100:115], v[200:203], v[176:179], v[100:115]
  v_exp_f32 v140, v140
  v_exp_f32 v141, v141
  v_cvt_pk_bf16_f32 v166, v136, v137
  v_cvt_pk_bf16_f32 v167, v138, v139
  v_smfmac_f32_16x16x64_bf16 v[128:131], v[16:19], v[172:179], v8
  ds_read_b128 v[180:183], v2 offset:12288
  v_exp_f32 v142, v142
  v_exp_f32 v143, v143
  v_cvt_pk_bf16_f32 v168, v140, v141
  v_exp_f32 v144, v144
  v_exp_f32 v145, v145
  v_cvt_pk_bf16_f32 v169, v142, v143
  v_exp_f32 v146, v146
  v_exp_f32 v147, v147
  v_cvt_pk_bf16_f32 v170, v144, v145
  v_cvt_pk_bf16_f32 v171, v146, v147
  v_mfma_f32_32x32x16_bf16 v[132:147], v[188:191], v[36:39], 0
  v_exp_f32 v148, v148
  v_exp_f32 v149, v149
  v_exp_f32 v150, v150
  v_mfma_f32_32x32x16_bf16 v[52:67], v[204:207], v[164:167], v[52:67]
  v_exp_f32 v151, v151
  v_exp_f32 v152, v152
  v_exp_f32 v153, v153
  v_mfma_f32_32x32x16_bf16 v[132:147], v[192:195], v[40:43], v[132:147]
  v_exp_f32 v154, v154
  v_exp_f32 v155, v155
  v_cvt_pk_bf16_f32 v172, v148, v149
  v_cvt_pk_bf16_f32 v173, v150, v151
  v_mfma_f32_32x32x16_bf16 v[52:67], v[208:211], v[168:171], v[52:67]
  v_exp_f32 v156, v156
  v_exp_f32 v157, v157
  v_cvt_pk_bf16_f32 v174, v152, v153
  v_cvt_pk_bf16_f32 v175, v154, v155
  v_smfmac_f32_16x16x64_bf16 v[116:119], v[16:19], v[164:171], v8
  ds_read_b128 v[184:187], v2 offset:13312
  v_exp_f32 v158, v158
  v_exp_f32 v159, v159
  v_cvt_pk_bf16_f32 v176, v156, v157
  v_exp_f32 v160, v160
  v_exp_f32 v161, v161
  v_cvt_pk_bf16_f32 v177, v158, v159
  v_exp_f32 v162, v162
  v_exp_f32 v163, v163
  v_cvt_pk_bf16_f32 v178, v160, v161
  v_cvt_pk_bf16_f32 v179, v162, v163
  v_mfma_f32_32x32x16_bf16 v[148:163], v[188:191], v[44:47], 0
  v_exp_f32 v132, v132
  v_exp_f32 v133, v133
  v_exp_f32 v134, v134
  v_mfma_f32_32x32x16_bf16 v[68:83], v[204:207], v[172:175], v[68:83]
  v_exp_f32 v135, v135
  v_exp_f32 v136, v136
  v_exp_f32 v137, v137
  v_mfma_f32_32x32x16_bf16 v[148:163], v[192:195], v[48:51], v[148:163]
  v_exp_f32 v138, v138
  v_exp_f32 v139, v139
  v_cvt_pk_bf16_f32 v164, v132, v133
  v_cvt_pk_bf16_f32 v165, v134, v135
  v_mfma_f32_32x32x16_bf16 v[68:83], v[208:211], v[176:179], v[68:83]
  v_exp_f32 v140, v140
  v_exp_f32 v141, v141
  v_cvt_pk_bf16_f32 v166, v136, v137
  v_cvt_pk_bf16_f32 v167, v138, v139
  v_smfmac_f32_16x16x64_bf16 v[120:123], v[16:19], v[172:179], v8
  ds_read_b128 v[196:199], v2 offset:28672
  ds_read_b128 v[200:203], v2 offset:29696
  v_exp_f32 v142, v142
  v_exp_f32 v143, v143
  v_cvt_pk_bf16_f32 v168, v140, v141
  v_exp_f32 v144, v144
  v_exp_f32 v145, v145
  v_cvt_pk_bf16_f32 v169, v142, v143
  v_exp_f32 v146, v146
  v_exp_f32 v147, v147
  v_cvt_pk_bf16_f32 v170, v144, v145
  v_cvt_pk_bf16_f32 v171, v146, v147
  s_waitcnt lgkmcnt(0)
  v_mfma_f32_32x32x16_bf16 v[132:147], v[180:183], v[20:23], 0
  v_exp_f32 v148, v148
  v_exp_f32 v149, v149
  v_exp_f32 v150, v150
  v_mfma_f32_32x32x16_bf16 v[84:99], v[204:207], v[164:167], v[84:99]
  v_exp_f32 v151, v151
  v_exp_f32 v152, v152
  v_exp_f32 v153, v153
  v_mfma_f32_32x32x16_bf16 v[132:147], v[184:187], v[24:27], v[132:147]
  v_exp_f32 v154, v154
  v_exp_f32 v155, v155
  v_cvt_pk_bf16_f32 v172, v148, v149
  v_cvt_pk_bf16_f32 v173, v150, v151
  v_mfma_f32_32x32x16_bf16 v[84:99], v[208:211], v[168:171], v[84:99]
  v_exp_f32 v156, v156
  v_exp_f32 v157, v157
  v_cvt_pk_bf16_f32 v174, v152, v153
  v_cvt_pk_bf16_f32 v175, v154, v155
  v_smfmac_f32_16x16x64_bf16 v[124:127], v[16:19], v[164:171], v8
  v_exp_f32 v158, v158
  v_exp_f32 v159, v159
  v_cvt_pk_bf16_f32 v176, v156, v157
  v_exp_f32 v160, v160
  v_exp_f32 v161, v161
  v_cvt_pk_bf16_f32 v177, v158, v159
  v_exp_f32 v162, v162
  v_exp_f32 v163, v163
  v_cvt_pk_bf16_f32 v178, v160, v161
  v_cvt_pk_bf16_f32 v179, v162, v163
  v_mfma_f32_32x32x16_bf16 v[148:163], v[180:183], v[28:31], 0
  v_exp_f32 v132, v132
  v_exp_f32 v133, v133
  v_exp_f32 v134, v134
  v_mfma_f32_32x32x16_bf16 v[100:115], v[204:207], v[172:175], v[100:115]
  v_exp_f32 v135, v135
  v_exp_f32 v136, v136
  v_exp_f32 v137, v137
  v_mfma_f32_32x32x16_bf16 v[148:163], v[184:187], v[32:35], v[148:163]
  v_exp_f32 v138, v138
  v_exp_f32 v139, v139
  v_cvt_pk_bf16_f32 v164, v132, v133
  v_cvt_pk_bf16_f32 v165, v134, v135
  v_mfma_f32_32x32x16_bf16 v[100:115], v[208:211], v[176:179], v[100:115]
  v_exp_f32 v140, v140
  v_exp_f32 v141, v141
  v_cvt_pk_bf16_f32 v166, v136, v137
  v_cvt_pk_bf16_f32 v167, v138, v139
  v_smfmac_f32_16x16x64_bf16 v[128:131], v[16:19], v[172:179], v8
  ds_read_b128 v[188:191], v2 offset:14336
  v_exp_f32 v142, v142
  v_exp_f32 v143, v143
  v_cvt_pk_bf16_f32 v168, v140, v141
  v_exp_f32 v144, v144
  v_exp_f32 v145, v145
  v_cvt_pk_bf16_f32 v169, v142, v143
  v_exp_f32 v146, v146
  v_exp_f32 v147, v147
  v_cvt_pk_bf16_f32 v170, v144, v145
  v_cvt_pk_bf16_f32 v171, v146, v147
  v_mfma_f32_32x32x16_bf16 v[132:147], v[180:183], v[36:39], 0
  v_exp_f32 v148, v148
  v_exp_f32 v149, v149
  v_exp_f32 v150, v150
  v_mfma_f32_32x32x16_bf16 v[52:67], v[196:199], v[164:167], v[52:67]
  v_exp_f32 v151, v151
  v_exp_f32 v152, v152
  v_exp_f32 v153, v153
  v_mfma_f32_32x32x16_bf16 v[132:147], v[184:187], v[40:43], v[132:147]
  v_exp_f32 v154, v154
  v_exp_f32 v155, v155
  v_cvt_pk_bf16_f32 v172, v148, v149
  v_cvt_pk_bf16_f32 v173, v150, v151
  v_mfma_f32_32x32x16_bf16 v[52:67], v[200:203], v[168:171], v[52:67]
  v_exp_f32 v156, v156
  v_exp_f32 v157, v157
  v_cvt_pk_bf16_f32 v174, v152, v153
  v_cvt_pk_bf16_f32 v175, v154, v155
  v_smfmac_f32_16x16x64_bf16 v[116:119], v[16:19], v[164:171], v8
  ds_read_b128 v[192:195], v2 offset:15360
  v_exp_f32 v158, v158
  v_exp_f32 v159, v159
  v_cvt_pk_bf16_f32 v176, v156, v157
  v_exp_f32 v160, v160
  v_exp_f32 v161, v161
  v_cvt_pk_bf16_f32 v177, v158, v159
  v_exp_f32 v162, v162
  v_exp_f32 v163, v163
  v_cvt_pk_bf16_f32 v178, v160, v161
  v_cvt_pk_bf16_f32 v179, v162, v163
  v_mfma_f32_32x32x16_bf16 v[148:163], v[180:183], v[44:47], 0
  v_exp_f32 v132, v132
  v_exp_f32 v133, v133
  v_exp_f32 v134, v134
  v_mfma_f32_32x32x16_bf16 v[68:83], v[196:199], v[172:175], v[68:83]
  v_exp_f32 v135, v135
  v_exp_f32 v136, v136
  v_exp_f32 v137, v137
  v_mfma_f32_32x32x16_bf16 v[148:163], v[184:187], v[48:51], v[148:163]
  v_exp_f32 v138, v138
  v_exp_f32 v139, v139
  v_cvt_pk_bf16_f32 v164, v132, v133
  v_cvt_pk_bf16_f32 v165, v134, v135
  v_mfma_f32_32x32x16_bf16 v[68:83], v[200:203], v[176:179], v[68:83]
  v_exp_f32 v140, v140
  v_exp_f32 v141, v141
  v_cvt_pk_bf16_f32 v166, v136, v137
  v_cvt_pk_bf16_f32 v167, v138, v139
  v_smfmac_f32_16x16x64_bf16 v[120:123], v[16:19], v[172:179], v8
  ds_read_b128 v[204:207], v2 offset:30720
  ds_read_b128 v[208:211], v2 offset:31744
  v_exp_f32 v142, v142
  v_exp_f32 v143, v143
  v_cvt_pk_bf16_f32 v168, v140, v141
  v_exp_f32 v144, v144
  v_exp_f32 v145, v145
  v_cvt_pk_bf16_f32 v169, v142, v143
  v_exp_f32 v146, v146
  v_exp_f32 v147, v147
  v_cvt_pk_bf16_f32 v170, v144, v145
  v_cvt_pk_bf16_f32 v171, v146, v147
  s_waitcnt lgkmcnt(0)
  v_mfma_f32_32x32x16_bf16 v[132:147], v[188:191], v[20:23], 0
  v_exp_f32 v148, v148
  v_exp_f32 v149, v149
  v_exp_f32 v150, v150
  v_mfma_f32_32x32x16_bf16 v[84:99], v[196:199], v[164:167], v[84:99]
  v_exp_f32 v151, v151
  v_exp_f32 v152, v152
  v_exp_f32 v153, v153
  v_mfma_f32_32x32x16_bf16 v[132:147], v[192:195], v[24:27], v[132:147]
  v_exp_f32 v154, v154
  v_exp_f32 v155, v155
  v_cvt_pk_bf16_f32 v172, v148, v149
  v_cvt_pk_bf16_f32 v173, v150, v151
  v_mfma_f32_32x32x16_bf16 v[84:99], v[200:203], v[168:171], v[84:99]
  v_exp_f32 v156, v156
  v_exp_f32 v157, v157
  v_cvt_pk_bf16_f32 v174, v152, v153
  v_cvt_pk_bf16_f32 v175, v154, v155
  v_smfmac_f32_16x16x64_bf16 v[124:127], v[16:19], v[164:171], v8
  v_exp_f32 v158, v158
  v_exp_f32 v159, v159
  v_cvt_pk_bf16_f32 v176, v156, v157
  v_exp_f32 v160, v160
  v_exp_f32 v161, v161
  v_cvt_pk_bf16_f32 v177, v158, v159
  v_exp_f32 v162, v162
  v_exp_f32 v163, v163
  v_cvt_pk_bf16_f32 v178, v160, v161
  v_cvt_pk_bf16_f32 v179, v162, v163
  s_barrier
  v_mfma_f32_32x32x16_bf16 v[148:163], v[188:191], v[28:31], 0
  v_exp_f32 v132, v132
  v_exp_f32 v133, v133
  v_exp_f32 v134, v134
  v_mfma_f32_32x32x16_bf16 v[100:115], v[196:199], v[172:175], v[100:115]
  v_exp_f32 v135, v135
  v_exp_f32 v136, v136
  v_exp_f32 v137, v137
  v_mfma_f32_32x32x16_bf16 v[148:163], v[192:195], v[32:35], v[148:163]
  v_exp_f32 v138, v138
  v_exp_f32 v139, v139
  v_cvt_pk_bf16_f32 v164, v132, v133
  v_cvt_pk_bf16_f32 v165, v134, v135
  v_mfma_f32_32x32x16_bf16 v[100:115], v[200:203], v[176:179], v[100:115]
  v_exp_f32 v140, v140
  v_exp_f32 v141, v141
  v_cvt_pk_bf16_f32 v166, v136, v137
  v_cvt_pk_bf16_f32 v167, v138, v139
  v_smfmac_f32_16x16x64_bf16 v[128:131], v[16:19], v[172:179], v8
  ds_read_b128 v[180:183], v3 offset:0
  v_exp_f32 v142, v142
  v_exp_f32 v143, v143
  v_cvt_pk_bf16_f32 v168, v140, v141
  v_exp_f32 v144, v144
  v_exp_f32 v145, v145
  v_cvt_pk_bf16_f32 v169, v142, v143
  v_exp_f32 v146, v146
  v_exp_f32 v147, v147
  v_cvt_pk_bf16_f32 v170, v144, v145
  v_cvt_pk_bf16_f32 v171, v146, v147
  v_mfma_f32_32x32x16_bf16 v[132:147], v[188:191], v[36:39], 0
  v_exp_f32 v148, v148
  v_exp_f32 v149, v149
  v_exp_f32 v150, v150
  v_mfma_f32_32x32x16_bf16 v[52:67], v[204:207], v[164:167], v[52:67]
  v_exp_f32 v151, v151
  v_exp_f32 v152, v152
  v_exp_f32 v153, v153
  v_mfma_f32_32x32x16_bf16 v[132:147], v[192:195], v[40:43], v[132:147]
  v_exp_f32 v154, v154
  v_exp_f32 v155, v155
  v_cvt_pk_bf16_f32 v172, v148, v149
  v_cvt_pk_bf16_f32 v173, v150, v151
  v_mfma_f32_32x32x16_bf16 v[52:67], v[208:211], v[168:171], v[52:67]
  v_exp_f32 v156, v156
  v_exp_f32 v157, v157
  v_cvt_pk_bf16_f32 v174, v152, v153
  v_cvt_pk_bf16_f32 v175, v154, v155
  v_smfmac_f32_16x16x64_bf16 v[116:119], v[16:19], v[164:171], v8
  ds_read_b128 v[184:187], v3 offset:1024
  v_exp_f32 v158, v158
  v_exp_f32 v159, v159
  v_cvt_pk_bf16_f32 v176, v156, v157
  v_exp_f32 v160, v160
  v_exp_f32 v161, v161
  v_cvt_pk_bf16_f32 v177, v158, v159
  v_exp_f32 v162, v162
  v_exp_f32 v163, v163
  v_cvt_pk_bf16_f32 v178, v160, v161
  v_cvt_pk_bf16_f32 v179, v162, v163
  v_mfma_f32_32x32x16_bf16 v[148:163], v[188:191], v[44:47], 0
  v_exp_f32 v132, v132
  v_exp_f32 v133, v133
  v_exp_f32 v134, v134
  v_mfma_f32_32x32x16_bf16 v[68:83], v[204:207], v[172:175], v[68:83]
  v_exp_f32 v135, v135
  v_exp_f32 v136, v136
  v_exp_f32 v137, v137
  v_mfma_f32_32x32x16_bf16 v[148:163], v[192:195], v[48:51], v[148:163]
  v_exp_f32 v138, v138
  v_exp_f32 v139, v139
  v_cvt_pk_bf16_f32 v164, v132, v133
  v_cvt_pk_bf16_f32 v165, v134, v135
  v_mfma_f32_32x32x16_bf16 v[68:83], v[208:211], v[176:179], v[68:83]
  v_exp_f32 v140, v140
  v_exp_f32 v141, v141
  v_cvt_pk_bf16_f32 v166, v136, v137
  v_cvt_pk_bf16_f32 v167, v138, v139
  v_smfmac_f32_16x16x64_bf16 v[120:123], v[16:19], v[172:179], v8
  ds_read_b128 v[196:199], v3 offset:16384
  ds_read_b128 v[200:203], v3 offset:17408
  v_exp_f32 v142, v142
  v_exp_f32 v143, v143
  v_cvt_pk_bf16_f32 v168, v140, v141
  v_exp_f32 v144, v144
  v_exp_f32 v145, v145
  v_cvt_pk_bf16_f32 v169, v142, v143
  v_exp_f32 v146, v146
  v_exp_f32 v147, v147
  v_cvt_pk_bf16_f32 v170, v144, v145
  v_cvt_pk_bf16_f32 v171, v146, v147
  s_waitcnt lgkmcnt(0)
  v_mfma_f32_32x32x16_bf16 v[132:147], v[180:183], v[20:23], 0
  v_exp_f32 v148, v148
  v_exp_f32 v149, v149
  v_mov_b32 v2, v3
  v_exp_f32 v150, v150
  v_add_u32 v3, s22, v1
  v_mfma_f32_32x32x16_bf16 v[84:99], v[204:207], v[164:167], v[84:99]
  v_exp_f32 v151, v151
  s_add_u32 s22, s22, 32768
  v_exp_f32 v152, v152
  s_cmp_ge_u32 s22, 98304
  v_exp_f32 v153, v153
  s_cselect_b32 s25, 98304, 0
  v_mfma_f32_32x32x16_bf16 v[132:147], v[184:187], v[24:27], v[132:147]
  v_exp_f32 v154, v154
  s_sub_u32 s22, s22, s25
  v_exp_f32 v155, v155
  s_sub_u32 s19, s19, 1
  v_cvt_pk_bf16_f32 v172, v148, v149
  v_cvt_pk_bf16_f32 v173, v150, v151
  v_mfma_f32_32x32x16_bf16 v[84:99], v[208:211], v[168:171], v[84:99]
  v_exp_f32 v156, v156
  s_cmp_lg_u32 s19, 0
  v_exp_f32 v157, v157
  v_cvt_pk_bf16_f32 v174, v152, v153
  v_cvt_pk_bf16_f32 v175, v154, v155
  v_smfmac_f32_16x16x64_bf16 v[124:127], v[16:19], v[164:171], v8
  v_exp_f32 v158, v158
  v_exp_f32 v159, v159
  v_cvt_pk_bf16_f32 v176, v156, v157
  v_exp_f32 v160, v160
  v_exp_f32 v161, v161
  v_cvt_pk_bf16_f32 v177, v158, v159
  v_exp_f32 v162, v162
  v_exp_f32 v163, v163
  v_cvt_pk_bf16_f32 v178, v160, v161
  v_cvt_pk_bf16_f32 v179, v162, v163
  s_cbranch_scc1 L_attn_kernel_loop
  s_branch L_attn_kernel_bar2
L_attn_kernel_bar1:
  s_barrier
  s_branch L_attn_kernel_bar1r
L_attn_kernel_bar2:
  s_nop 1
  v_mfma_f32_32x32x16_bf16 v[100:115], v[204:207], v[172:175], v[100:115]
  v_mfma_f32_32x32x16_bf16 v[100:115], v[208:211], v[176:179], v[100:115]
  v_smfmac_f32_16x16x64_bf16 v[128:131], v[16:19], v[172:179], v8
L_attn_kernel_fin:
  s_nop 7
  s_nop 7
  v_mov_b32 v182, 0
  v_mov_b32 v183, 0
  v_mov_b32 v184, 0
  v_mov_b32 v185, 0
  s_mov_b32 s19, 0
  v_add_f32 v4, v116, v117
  v_rcp_f32 v180, v4
  v_mov_b32 v6, 0x35800000
  v_cmp_nle_f32 s[26:27], v6, v4
  v_mov_b32 v6, 0x71800000
  v_cmp_nle_f32 vcc, v4, v6
  v_mov_b32 v181, v180
  v_pk_mul_f32 v[52:53], v[52:53], v[180:181]
  v_pk_mul_f32 v[54:55], v[54:55], v[180:181]
  v_pk_mul_f32 v[56:57], v[56:57], v[180:181]
  v_pk_mul_f32 v[58:59], v[58:59], v[180:181]
  v_pk_mul_f32 v[60:61], v[60:61], v[180:181]
  v_pk_mul_f32 v[62:63], v[62:63], v[180:181]
  v_pk_mul_f32 v[64:65], v[64:65], v[180:181]
  v_pk_mul_f32 v[66:67], v[66:67], v[180:181]
  s_or_b64 vcc, vcc, s[26:27]
  s_cmp_lg_u64 vcc, 0
  s_cselect_b32 s24, 1, 0
  s_or_b32 s19, s19, s24
  v_cvt_pk_bf16_f32 v132, v52, v53
  v_cvt_pk_bf16_f32 v133, v54, v55
  v_cvt_pk_bf16_f32 v134, v56, v57
  v_cvt_pk_bf16_f32 v135, v58, v59
  v_cvt_pk_bf16_f32 v136, v60, v61
  v_cvt_pk_bf16_f32 v137, v62, v63
  v_cvt_pk_bf16_f32 v138, v64, v65
  v_cvt_pk_bf16_f32 v139, v66, v67
  buffer_store_dwordx4 v[132:135], v1, s[12:15], s21 offen offset:0 sc0 sc1
  buffer_store_dwordx4 v[136:139], v1, s[12:15], s21 offen offset:1024 sc0 sc1
  s_add_u32 s21, s21, 65536
  v_add_f32 v4, v120, v121
  v_rcp_f32 v180, v4
  v_mov_b32 v6, 0x35800000
  v_cmp_nle_f32 s[26:27], v6, v4
  v_mov_b32 v6, 0x71800000
  v_cmp_nle_f32 vcc, v4, v6
  v_mov_b32 v181, v180
  v_pk_mul_f32 v[68:69], v[68:69], v[180:181]
  v_pk_mul_f32 v[70:71], v[70:71], v[180:181]
  v_pk_mul_f32 v[72:73], v[72:73], v[180:181]
  v_pk_mul_f32 v[74:75], v[74:75], v[180:181]
  v_pk_mul_f32 v[76:77], v[76:77], v[180:181]
  v_pk_mul_f32 v[78:79], v[78:79], v[180:181]
  v_pk_mul_f32 v[80:81], v[80:81], v[180:181]
  v_pk_mul_f32 v[82:83], v[82:83], v[180:181]
  s_or_b64 vcc, vcc, s[26:27]
  s_cmp_lg_u64 vcc, 0
  s_cselect_b32 s24, 1, 0
  s_or_b32 s19, s19, s24
  v_cvt_pk_bf16_f32 v148, v68, v69
  v_cvt_pk_bf16_f32 v149, v70, v71
  v_cvt_pk_bf16_f32 v150, v72, v73
  v_cvt_pk_bf16_f32 v151, v74, v75
  v_cvt_pk_bf16_f32 v152, v76, v77
  v_cvt_pk_bf16_f32 v153, v78, v79
  v_cvt_pk_bf16_f32 v154, v80, v81
  v_cvt_pk_bf16_f32 v155, v82, v83
  buffer_store_dwordx4 v[148:151], v1, s[12:15], s21 offen offset:0 sc0 sc1
  buffer_store_dwordx4 v[152:155], v1, s[12:15], s21 offen offset:1024 sc0 sc1
  s_add_u32 s21, s21, 65536
  v_add_f32 v4, v124, v125
  v_rcp_f32 v180, v4
  v_mov_b32 v6, 0x35800000
  v_cmp_nle_f32 s[26:27], v6, v4
  v_mov_b32 v6, 0x71800000
  v_cmp_nle_f32 vcc, v4, v6
  v_mov_b32 v181, v180
  v_pk_mul_f32 v[84:85], v[84:85], v[180:181]
  v_pk_mul_f32 v[86:87], v[86:87], v[180:181]
  v_pk_mul_f32 v[88:89], v[88:89], v[180:181]
  v_pk_mul_f32 v[90:91], v[90:91], v[180:181]
  v_pk_mul_f32 v[92:93], v[92:93], v[180:181]
  v_pk_mul_f32 v[94:95], v[94:95], v[180:181]
  v_pk_mul_f32 v[96:97], v[96:97], v[180:181]
  v_pk_mul_f32 v[98:99], v[98:99], v[180:181]
  s_or_b64 vcc, vcc, s[26:27]
  s_cmp_lg_u64 vcc, 0
  s_cselect_b32 s24, 1, 0
  s_or_b32 s19, s19, s24
  v_cvt_pk_bf16_f32 v140, v84, v85
  v_cvt_pk_bf16_f32 v141, v86, v87
  v_cvt_pk_bf16_f32 v142, v88, v89
  v_cvt_pk_bf16_f32 v143, v90, v91
  v_cvt_pk_bf16_f32 v144, v92, v93
  v_cvt_pk_bf16_f32 v145, v94, v95
  v_cvt_pk_bf16_f32 v146, v96, v97
  v_cvt_pk_bf16_f32 v147, v98, v99
  buffer_store_dwordx4 v[140:143], v1, s[12:15], s21 offen offset:0 sc0 sc1
  buffer_store_dwordx4 v[144:147], v1, s[12:15], s21 offen offset:1024 sc0 sc1
  s_add_u32 s21, s21, 65536
  v_add_f32 v4, v128, v129
  v_rcp_f32 v180, v4
  v_mov_b32 v6, 0x35800000
  v_cmp_nle_f32 s[26:27], v6, v4
  v_mov_b32 v6, 0x71800000
  v_cmp_nle_f32 vcc, v4, v6
  v_mov_b32 v181, v180
  v_pk_mul_f32 v[100:101], v[100:101], v[180:181]
  v_pk_mul_f32 v[102:103], v[102:103], v[180:181]
  v_pk_mul_f32 v[104:105], v[104:105], v[180:181]
  v_pk_mul_f32 v[106:107], v[106:107], v[180:181]
  v_pk_mul_f32 v[108:109], v[108:109], v[180:181]
  v_pk_mul_f32 v[110:111], v[110:111], v[180:181]
  v_pk_mul_f32 v[112:113], v[112:113], v[180:181]
  v_pk_mul_f32 v[114:115], v[114:115], v[180:181]
  s_or_b64 vcc, vcc, s[26:27]
  s_cmp_lg_u64 vcc, 0
  s_cselect_b32 s24, 1, 0
  s_or_b32 s19, s19, s24
  v_cvt_pk_bf16_f32 v156, v100, v101
  v_cvt_pk_bf16_f32 v157, v102, v103
  v_cvt_pk_bf16_f32 v158, v104, v105
  v_cvt_pk_bf16_f32 v159, v106, v107
  v_cvt_pk_bf16_f32 v160, v108, v109
  v_cvt_pk_bf16_f32 v161, v110, v111
  v_cvt_pk_bf16_f32 v162, v112, v113
  v_cvt_pk_bf16_f32 v163, v114, v115
  buffer_store_dwordx4 v[156:159], v1, s[12:15], s21 offen offset:0 sc0 sc1
  buffer_store_dwordx4 v[160:163], v1, s[12:15], s21 offen offset:1024 sc0 sc1
  s_add_u32 s21, s21, 65536
  v_pk_fma_f32 v[182:183], v[52:53], v[184:185], v[182:183]
  v_pk_fma_f32 v[182:183], v[54:55], v[184:185], v[182:183]
  v_pk_fma_f32 v[182:183], v[56:57], v[184:185], v[182:183]
  v_pk_fma_f32 v[182:183], v[58:59], v[184:185], v[182:183]
  v_pk_fma_f32 v[182:183], v[60:61], v[184:185], v[182:183]
  v_pk_fma_f32 v[182:183], v[62:63], v[184:185], v[182:183]
  v_pk_fma_f32 v[182:183], v[64:65], v[184:185], v[182:183]
  v_pk_fma_f32 v[182:183], v[66:67], v[184:185], v[182:183]
  v_pk_fma_f32 v[182:183], v[68:69], v[184:185], v[182:183]
  v_pk_fma_f32 v[182:183], v[70:71], v[184:185], v[182:183]
  v_pk_fma_f32 v[182:183], v[72:73], v[184:185], v[182:183]
  v_pk_fma_f32 v[182:183], v[74:75], v[184:185], v[182:183]
  v_pk_fma_f32 v[182:183], v[76:77], v[184:185], v[182:183]
  v_pk_fma_f32 v[182:183], v[78:79], v[184:185], v[182:183]
  v_pk_fma_f32 v[182:183], v[80:81], v[184:185], v[182:183]
  v_pk_fma_f32 v[182:183], v[82:83], v[184:185], v[182:183]
  v_pk_fma_f32 v[182:183], v[84:85], v[184:185], v[182:183]
  v_pk_fma_f32 v[182:183], v[86:87], v[184:185], v[182:183]
  v_pk_fma_f32 v[182:183], v[88:89], v[184:185], v[182:183]
  v_pk_fma_f32 v[182:183], v[90:91], v[184:185], v[182:183]
  v_pk_fma_f32 v[182:183], v[92:93], v[184:185], v[182:183]
  v_pk_fma_f32 v[182:183], v[94:95], v[184:185], v[182:183]
  v_pk_fma_f32 v[182:183], v[96:97], v[184:185], v[182:183]
  v_pk_fma_f32 v[182:183], v[98:99], v[184:185], v[182:183]
  v_pk_fma_f32 v[182:183], v[100:101], v[184:185], v[182:183]
  v_pk_fma_f32 v[182:183], v[102:103], v[184:185], v[182:183]
  v_pk_fma_f32 v[182:183], v[104:105], v[184:185], v[182:183]
  v_pk_fma_f32 v[182:183], v[106:107], v[184:185], v[182:183]
  v_pk_fma_f32 v[182:183], v[108:109], v[184:185], v[182:183]
  v_pk_fma_f32 v[182:183], v[110:111], v[184:185], v[182:183]
  v_pk_fma_f32 v[182:183], v[112:113], v[184:185], v[182:183]
  v_pk_fma_f32 v[182:183], v[114:115], v[184:185], v[182:183]
  s_sub_u32 s21, s21, 262144
  v_add_f32 v7, v182, v183
  v_cmp_u_f32 vcc, v7, v7
  s_nop 3
  s_cmp_lg_u64 vcc, 0
  s_cselect_b32 s24, 1, 0
  s_or_b32 s19, s19, s24
  s_cmp_eq_u32 s23, 1
  s_cbranch_scc1 L_attn_kernel_done2
  v_mov_b32 v4, s19
  s_lshl_b32 s24, s16, 2
  s_add_u32 s24, s24, 32768
  v_mov_b32 v5, s24
  ds_write_b32 v5, v4
  v_mov_b32 v5, 32768
  s_waitcnt lgkmcnt(0)
  s_barrier
  ds_read_b128 v[188:191], v5
  s_waitcnt lgkmcnt(0)
  v_or3_b32 v4, v188, v189, v190
  v_or_b32 v4, v4, v191
  s_nop 1
  v_readfirstlane_b32 s24, v4
  s_nop 3
  s_cmp_eq_u32 s24, 0
  s_cbranch_scc1 L_attn_kernel_done
  s_waitcnt vmcnt(0)
  s_mov_b32 s23, 1
  s_mov_b32 s19, 8
  v_mov_b32 v52, 0
  v_mov_b32 v53, 0
  v_mov_b32 v54, 0
  v_mov_b32 v55, 0
  v_mov_b32 v56, 0
  v_mov_b32 v57, 0
  v_mov_b32 v58, 0
  v_mov_b32 v59, 0
  v_mov_b32 v60, 0
  v_mov_b32 v61, 0
  v_mov_b32 v62, 0
  v_mov_b32 v63, 0
  v_mov_b32 v64, 0
  v_mov_b32 v65, 0
  v_mov_b32 v66, 0
  v_mov_b32 v67, 0
  v_mov_b32 v116, 0
  v_mov_b32 v117, 0
  v_mov_b32 v68, 0
  v_mov_b32 v69, 0
  v_mov_b32 v70, 0
  v_mov_b32 v71, 0
  v_mov_b32 v72, 0
  v_mov_b32 v73, 0
  v_mov_b32 v74, 0
  v_mov_b32 v75, 0
  v_mov_b32 v76, 0
  v_mov_b32 v77, 0
  v_mov_b32 v78, 0
  v_mov_b32 v79, 0
  v_mov_b32 v80, 0
  v_mov_b32 v81, 0
  v_mov_b32 v82, 0
  v_mov_b32 v83, 0
  v_mov_b32 v120, 0
  v_mov_b32 v121, 0
  v_mov_b32 v84, 0
  v_mov_b32 v85, 0
  v_mov_b32 v86, 0
  v_mov_b32 v87, 0
  v_mov_b32 v88, 0
  v_mov_b32 v89, 0
  v_mov_b32 v90, 0
  v_mov_b32 v91, 0
  v_mov_b32 v92, 0
  v_mov_b32 v93, 0
  v_mov_b32 v94, 0
  v_mov_b32 v95, 0
  v_mov_b32 v96, 0
  v_mov_b32 v97, 0
  v_mov_b32 v98, 0
  v_mov_b32 v99, 0
  v_mov_b32 v124, 0
  v_mov_b32 v125, 0
  v_mov_b32 v100, 0
  v_mov_b32 v101, 0
  v_mov_b32 v102, 0
  v_mov_b32 v103, 0
  v_mov_b32 v104, 0
  v_mov_b32 v105, 0
  v_mov_b32 v106, 0
  v_mov_b32 v107, 0
  v_mov_b32 v108, 0
  v_mov_b32 v109, 0
  v_mov_b32 v110, 0
  v_mov_b32 v111, 0
  v_mov_b32 v112, 0
  v_mov_b32 v113, 0
  v_mov_b32 v114, 0
  v_mov_b32 v115, 0
  v_mov_b32 v128, 0
  v_mov_b32 v129, 0
  v_mov_b32 v11, 0xff7fffff
  v_mov_b32 v12, 0xff7fffff
  v_mov_b32 v13, 0xff7fffff
  v_mov_b32 v14, 0xff7fffff
L_attn_kernel_slow:
  s_barrier
  s_barrier
  v_mov_b32 v2, v1
  s_mov_b32 s22, 8
L_attn_kernel_slowt:
  ds_read_b128 v[180:183], v2 offset:0
  ds_read_b128 v[184:187], v2 offset:1024
  ds_read_b128 v[196:199], v2 offset:16384
  ds_read_b128 v[200:203], v2 offset:17408
  v_add_u32 v2, 2048, v2
  s_waitcnt lgkmcnt(0)
  v_mfma_f32_32x32x16_bf16 v[132:147], v[180:183], v[20:23], 0
  v_mfma_f32_32x32x16_bf16 v[132:147], v[184:187], v[24:27], v[132:147]
  s_nop 7
  s_nop 3
  v_max3_f32 v4, v132, v133, v134
  v_max3_f32 v4, v4, v135, v136
  v_max3_f32 v4, v4, v137, v138
  v_max3_f32 v4, v4, v139, v140
  v_max3_f32 v4, v4, v141, v142
  v_max3_f32 v4, v4, v143, v144
  v_max3_f32 v4, v4, v145, v146
  v_max_f32 v4, v4, v147
  v_mov_b32 v5, v4
  s_nop 1
  v_permlane32_swap_b32 v4, v5
  v_max3_f32 v4, v4, v5, v11
  v_sub_f32 v9, v11, v4
  v_exp_f32 v9, v9
  v_mov_b32 v11, v4
  v_sub_f32 v132, v132, v4
  v_sub_f32 v133, v133, v4
  v_sub_f32 v134, v134, v4
  v_sub_f32 v135, v135, v4
  v_sub_f32 v136, v136, v4
  v_sub_f32 v137, v137, v4
  v_sub_f32 v138, v138, v4
  v_sub_f32 v139, v139, v4
  v_sub_f32 v140, v140, v4
  v_sub_f32 v141, v141, v4
  v_sub_f32 v142, v142, v4
  v_sub_f32 v143, v143, v4
  v_sub_f32 v144, v144, v4
  v_sub_f32 v145, v145, v4
  v_sub_f32 v146, v146, v4
  v_sub_f32 v147, v147, v4
  v_exp_f32 v132, v132
  v_exp_f32 v133, v133
  v_exp_f32 v134, v134
  v_exp_f32 v135, v135
  v_exp_f32 v136, v136
  v_exp_f32 v137, v137
  v_exp_f32 v138, v138
  v_exp_f32 v139, v139
  v_exp_f32 v140, v140
  v_exp_f32 v141, v141
  v_exp_f32 v142, v142
  v_exp_f32 v143, v143
  v_exp_f32 v144, v144
  v_exp_f32 v145, v145
  v_exp_f32 v146, v146
  v_exp_f32 v147, v147
  v_mul_f32 v52, v52, v9
  v_mul_f32 v53, v53, v9
  v_mul_f32 v54, v54, v9
  v_mul_f32 v55, v55, v9
  v_mul_f32 v56, v56, v9
  v_mul_f32 v57, v57, v9
  v_mul_f32 v58, v58, v9
  v_mul_f32 v59, v59, v9
  v_mul_f32 v60, v60, v9
  v_mul_f32 v61, v61, v9
  v_mul_f32 v62, v62, v9
  v_mul_f32 v63, v63, v9
  v_mul_f32 v64, v64, v9
  v_mul_f32 v65, v65, v9
  v_mul_f32 v66, v66, v9
  v_mul_f32 v67, v67, v9
  v_mul_f32 v116, v116, v9
  v_mul_f32 v117, v117, v9
  v_cvt_pk_bf16_f32 v164, v132, v133
  v_cvt_pk_bf16_f32 v165, v134, v135
  v_cvt_pk_bf16_f32 v166, v136, v137
  v_cvt_pk_bf16_f32 v167, v138, v139
  v_cvt_pk_bf16_f32 v168, v140, v141
  v_cvt_pk_bf16_f32 v169, v142, v143
  v_cvt_pk_bf16_f32 v170, v144, v145
  v_cvt_pk_bf16_f32 v171, v146, v147
  s_nop 1
  v_mfma_f32_32x32x16_bf16 v[52:67], v[196:199], v[164:167], v[52:67]
  v_mfma_f32_32x32x16_bf16 v[52:67], v[200:203], v[168:171], v[52:67]
  v_smfmac_f32_16x16x64_bf16 v[116:119], v[16:19], v[164:171], v8
  s_nop 7
  s_nop 7
  v_mfma_f32_32x32x16_bf16 v[132:147], v[180:183], v[28:31], 0
  v_mfma_f32_32x32x16_bf16 v[132:147], v[184:187], v[32:35], v[132:147]
  s_nop 7
  s_nop 3
  v_max3_f32 v4, v132, v133, v134
  v_max3_f32 v4, v4, v135, v136
  v_max3_f32 v4, v4, v137, v138
  v_max3_f32 v4, v4, v139, v140
  v_max3_f32 v4, v4, v141, v142
  v_max3_f32 v4, v4, v143, v144
  v_max3_f32 v4, v4, v145, v146
  v_max_f32 v4, v4, v147
  v_mov_b32 v5, v4
  s_nop 1
  v_permlane32_swap_b32 v4, v5
  v_max3_f32 v4, v4, v5, v12
  v_sub_f32 v9, v12, v4
  v_exp_f32 v9, v9
  v_mov_b32 v12, v4
  v_sub_f32 v132, v132, v4
  v_sub_f32 v133, v133, v4
  v_sub_f32 v134, v134, v4
  v_sub_f32 v135, v135, v4
  v_sub_f32 v136, v136, v4
  v_sub_f32 v137, v137, v4
  v_sub_f32 v138, v138, v4
  v_sub_f32 v139, v139, v4
  v_sub_f32 v140, v140, v4
  v_sub_f32 v141, v141, v4
  v_sub_f32 v142, v142, v4
  v_sub_f32 v143, v143, v4
  v_sub_f32 v144, v144, v4
  v_sub_f32 v145, v145, v4
  v_sub_f32 v146, v146, v4
  v_sub_f32 v147, v147, v4
  v_exp_f32 v132, v132
  v_exp_f32 v133, v133
  v_exp_f32 v134, v134
  v_exp_f32 v135, v135
  v_exp_f32 v136, v136
  v_exp_f32 v137, v137
  v_exp_f32 v138, v138
  v_exp_f32 v139, v139
  v_exp_f32 v140, v140
  v_exp_f32 v141, v141
  v_exp_f32 v142, v142
  v_exp_f32 v143, v143
  v_exp_f32 v144, v144
  v_exp_f32 v145, v145
  v_exp_f32 v146, v146
  v_exp_f32 v147, v147
  v_mul_f32 v68, v68, v9
  v_mul_f32 v69, v69, v9
  v_mul_f32 v70, v70, v9
  v_mul_f32 v71, v71, v9
  v_mul_f32 v72, v72, v9
  v_mul_f32 v73, v73, v9
  v_mul_f32 v74, v74, v9
  v_mul_f32 v75, v75, v9
  v_mul_f32 v76, v76, v9
  v_mul_f32 v77, v77, v9
  v_mul_f32 v78, v78, v9
  v_mul_f32 v79, v79, v9
  v_mul_f32 v80, v80, v9
  v_mul_f32 v81, v81, v9
  v_mul_f32 v82, v82, v9
  v_mul_f32 v83, v83, v9
  v_mul_f32 v120, v120, v9
  v_mul_f32 v121, v121, v9
  v_cvt_pk_bf16_f32 v164, v132, v133
  v_cvt_pk_bf16_f32 v165, v134, v135
  v_cvt_pk_bf16_f32 v166, v136, v137
  v_cvt_pk_bf16_f32 v167, v138, v139
  v_cvt_pk_bf16_f32 v168, v140, v141
  v_cvt_pk_bf16_f32 v169, v142, v143
  v_cvt_pk_bf16_f32 v170, v144, v145
  v_cvt_pk_bf16_f32 v171, v146, v147
  s_nop 1
  v_mfma_f32_32x32x16_bf16 v[68:83], v[196:199], v[164:167], v[68:83]
  v_mfma_f32_32x32x16_bf16 v[68:83], v[200:203], v[168:171], v[68:83]
  v_smfmac_f32_16x16x64_bf16 v[120:123], v[16:19], v[164:171], v8
  s_nop 7
  s_nop 7
  v_mfma_f32_32x32x16_bf16 v[132:147], v[180:183], v[36:39], 0
  v_mfma_f32_32x32x16_bf16 v[132:147], v[184:187], v[40:43], v[132:147]
  s_nop 7
  s_nop 3
  v_max3_f32 v4, v132, v133, v134
  v_max3_f32 v4, v4, v135, v136
  v_max3_f32 v4, v4, v137, v138
  v_max3_f32 v4, v4, v139, v140
  v_max3_f32 v4, v4, v141, v142
  v_max3_f32 v4, v4, v143, v144
  v_max3_f32 v4, v4, v145, v146
  v_max_f32 v4, v4, v147
  v_mov_b32 v5, v4
  s_nop 1
  v_permlane32_swap_b32 v4, v5
  v_max3_f32 v4, v4, v5, v13
  v_sub_f32 v9, v13, v4
  v_exp_f32 v9, v9
  v_mov_b32 v13, v4
  v_sub_f32 v132, v132, v4
  v_sub_f32 v133, v133, v4
  v_sub_f32 v134, v134, v4
  v_sub_f32 v135, v135, v4
  v_sub_f32 v136, v136, v4
  v_sub_f32 v137, v137, v4
  v_sub_f32 v138, v138, v4
  v_sub_f32 v139, v139, v4
  v_sub_f32 v140, v140, v4
  v_sub_f32 v141, v141, v4
  v_sub_f32 v142, v142, v4
  v_sub_f32 v143, v143, v4
  v_sub_f32 v144, v144, v4
  v_sub_f32 v145, v145, v4
  v_sub_f32 v146, v146, v4
  v_sub_f32 v147, v147, v4
  v_exp_f32 v132, v132
  v_exp_f32 v133, v133
  v_exp_f32 v134, v134
  v_exp_f32 v135, v135
  v_exp_f32 v136, v136
  v_exp_f32 v137, v137
  v_exp_f32 v138, v138
  v_exp_f32 v139, v139
  v_exp_f32 v140, v140
  v_exp_f32 v141, v141
  v_exp_f32 v142, v142
  v_exp_f32 v143, v143
  v_exp_f32 v144, v144
  v_exp_f32 v145, v145
  v_exp_f32 v146, v146
  v_exp_f32 v147, v147
  v_mul_f32 v84, v84, v9
  v_mul_f32 v85, v85, v9
  v_mul_f32 v86, v86, v9
  v_mul_f32 v87, v87, v9
  v_mul_f32 v88, v88, v9
  v_mul_f32 v89, v89, v9
  v_mul_f32 v90, v90, v9
  v_mul_f32 v91, v91, v9
  v_mul_f32 v92, v92, v9
  v_mul_f32 v93, v93, v9
  v_mul_f32 v94, v94, v9
  v_mul_f32 v95, v95, v9
  v_mul_f32 v96, v96, v9
  v_mul_f32 v97, v97, v9
  v_mul_f32 v98, v98, v9
  v_mul_f32 v99, v99, v9
  v_mul_f32 v124, v124, v9
  v_mul_f32 v125, v125, v9
  v_cvt_pk_bf16_f32 v164, v132, v133
  v_cvt_pk_bf16_f32 v165, v134, v135
  v_cvt_pk_bf16_f32 v166, v136, v137
  v_cvt_pk_bf16_f32 v167, v138, v139
  v_cvt_pk_bf16_f32 v168, v140, v141
  v_cvt_pk_bf16_f32 v169, v142, v143
  v_cvt_pk_bf16_f32 v170, v144, v145
  v_cvt_pk_bf16_f32 v171, v146, v147
  s_nop 1
  v_mfma_f32_32x32x16_bf16 v[84:99], v[196:199], v[164:167], v[84:99]
  v_mfma_f32_32x32x16_bf16 v[84:99], v[200:203], v[168:171], v[84:99]
  v_smfmac_f32_16x16x64_bf16 v[124:127], v[16:19], v[164:171], v8
  s_nop 7
  s_nop 7
  v_mfma_f32_32x32x16_bf16 v[132:147], v[180:183], v[44:47], 0
  v_mfma_f32_32x32x16_bf16 v[132:147], v[184:187], v[48:51], v[132:147]
  s_nop 7
  s_nop 3
  v_max3_f32 v4, v132, v133, v134
  v_max3_f32 v4, v4, v135, v136
  v_max3_f32 v4, v4, v137, v138
  v_max3_f32 v4, v4, v139, v140
  v_max3_f32 v4, v4, v141, v142
  v_max3_f32 v4, v4, v143, v144
  v_max3_f32 v4, v4, v145, v146
  v_max_f32 v4, v4, v147
  v_mov_b32 v5, v4
  s_nop 1
  v_permlane32_swap_b32 v4, v5
  v_max3_f32 v4, v4, v5, v14
  v_sub_f32 v9, v14, v4
  v_exp_f32 v9, v9
  v_mov_b32 v14, v4
  v_sub_f32 v132, v132, v4
  v_sub_f32 v133, v133, v4
  v_sub_f32 v134, v134, v4
  v_sub_f32 v135, v135, v4
  v_sub_f32 v136, v136, v4
  v_sub_f32 v137, v137, v4
  v_sub_f32 v138, v138, v4
  v_sub_f32 v139, v139, v4
  v_sub_f32 v140, v140, v4
  v_sub_f32 v141, v141, v4
  v_sub_f32 v142, v142, v4
  v_sub_f32 v143, v143, v4
  v_sub_f32 v144, v144, v4
  v_sub_f32 v145, v145, v4
  v_sub_f32 v146, v146, v4
  v_sub_f32 v147, v147, v4
  v_exp_f32 v132, v132
  v_exp_f32 v133, v133
  v_exp_f32 v134, v134
  v_exp_f32 v135, v135
  v_exp_f32 v136, v136
  v_exp_f32 v137, v137
  v_exp_f32 v138, v138
  v_exp_f32 v139, v139
  v_exp_f32 v140, v140
  v_exp_f32 v141, v141
  v_exp_f32 v142, v142
  v_exp_f32 v143, v143
  v_exp_f32 v144, v144
  v_exp_f32 v145, v145
  v_exp_f32 v146, v146
  v_exp_f32 v147, v147
  v_mul_f32 v100, v100, v9
  v_mul_f32 v101, v101, v9
  v_mul_f32 v102, v102, v9
  v_mul_f32 v103, v103, v9
  v_mul_f32 v104, v104, v9
  v_mul_f32 v105, v105, v9
  v_mul_f32 v106, v106, v9
  v_mul_f32 v107, v107, v9
  v_mul_f32 v108, v108, v9
  v_mul_f32 v109, v109, v9
  v_mul_f32 v110, v110, v9
  v_mul_f32 v111, v111, v9
  v_mul_f32 v112, v112, v9
  v_mul_f32 v113, v113, v9
  v_mul_f32 v114, v114, v9
  v_mul_f32 v115, v115, v9
  v_mul_f32 v128, v128, v9
  v_mul_f32 v129, v129, v9
  v_cvt_pk_bf16_f32 v164, v132, v133
  v_cvt_pk_bf16_f32 v165, v134, v135
  v_cvt_pk_bf16_f32 v166, v136, v137
  v_cvt_pk_bf16_f32 v167, v138, v139
  v_cvt_pk_bf16_f32 v168, v140, v141
  v_cvt_pk_bf16_f32 v169, v142, v143
  v_cvt_pk_bf16_f32 v170, v144, v145
  v_cvt_pk_bf16_f32 v171, v146, v147
  s_nop 1
  v_mfma_f32_32x32x16_bf16 v[100:115], v[196:199], v[164:167], v[100:115]
  v_mfma_f32_32x32x16_bf16 v[100:115], v[200:203], v[168:171], v[100:115]
  v_smfmac_f32_16x16x64_bf16 v[128:131], v[16:19], v[164:171], v8
  s_nop 7
  s_nop 7
  s_sub_u32 s22, s22, 1
  s_cmp_lg_u32 s22, 0
  s_cbranch_scc1 L_attn_kernel_slowt
  s_sub_u32 s19, s19, 1
  s_cmp_lg_u32 s19, 0
  s_cbranch_scc1 L_attn_kernel_slow
  s_branch L_attn_kernel_fin
L_attn_kernel_done2:
  s_barrier
L_attn_kernel_done:
  v_mov_b32 v164, s100
  v_mov_b32 v165, s101
  s_add_u32 s92, s4, 31457280
  s_addc_u32 s93, s5, 0
  s_and_b32 s93, s93, 0xffff
  s_mov_b32 s94, 393216
  s_mov_b32 s95, 0x20000
  s_lshl_b32 s24, s29, 4
  s_lshl_b32 s25, s30, 2
  s_add_u32 s24, s24, s25
  s_add_u32 s24, s24, s16
  s_lshl_b32 s24, s24, 5
  s_add_u32 s24, s24, s28
  s_mul_i32 s24, s24, 128
  s_add_u32 s24, s24, 262144
  v_mbcnt_lo_u32_b32 v4, -1, 0
  v_mbcnt_hi_u32_b32 v4, -1, v4
  v_mov_b32 v166, v164
  v_mov_b32 v167, v165
  v_lshlrev_b32 v4, 4, v4
  s_waitcnt vmcnt(0)
  s_mov_b32 exec_lo, 255
  s_mov_b32 exec_hi, 0
  buffer_store_dwordx4 v[164:167], v4, s[92:95], s24 offen sc0 sc1
  s_mov_b64 exec, -1
L_attn_kernel_end:
L_oproj_code:
  s_load_dwordx2 s[48:49], s[0:1], 80
  s_load_dwordx2 s[50:51], s[0:1], 32
  s_load_dwordx2 s[52:53], s[0:1], 56
  s_load_dwordx2 s[54:55], s[0:1], 64
  s_mov_b32 s24, s3
  s_and_b32 s30, s2, 7
  s_lshr_b32 s31, s2, 3
  s_lshr_b32 s25, s30, 2
  s_bfe_u32 s32, s30, 0x10001
  s_lshl_b32 s32, s32, 3
  s_and_b32 s26, s31, 7
  s_add_u32 s26, s26, s32
  s_and_b32 s32, s30, 1
  s_lshl_b32 s32, s32, 2
  s_lshr_b32 s27, s31, 3
  s_add_u32 s27, s27, s32
  s_waitcnt lgkmcnt(0)
  s_mul_i32 s30, s25, 4194304
  s_lshl_b32 s31, s26, 18
  s_add_u32 s30, s30, s31
  s_add_u32 s30, s30, 17825792
  s_add_u32 s8, s48, s30
  s_addc_u32 s9, s49, 0
  s_and_b32 s9, s9, 0xffff
  s_mov_b32 s10, 262144
  s_mov_b32 s11, 0x20000
  s_cmp_eq_u32 s25, 0
  s_cselect_b32 s32, s50, s52
  s_cselect_b32 s33, s51, s53
  s_lshl_b32 s30, s27, 8
  s_add_u32 s12, s32, s30
  s_addc_u32 s13, s33, 0
  s_and_b32 s13, s13, 0xffff
  s_sub_u32 s14, 2097152, s30
  s_mov_b32 s15, 0x20000
  s_mov_b32 s16, s54
  s_and_b32 s17, s55, 0xffff
  s_mov_b32 s18, 8388608
  s_mov_b32 s19, 0x20000
  s_cmp_lt_u32 s24, 4
  s_cbranch_scc1 L_oproj_kernel_compute
L_oproj_kernel_loader:
  s_sub_u32 s24, s24, 4
  s_lshl_b32 s30, s24, 16
  v_lshlrev_b32 v80, 4, v0
  v_add_u32 v80, s30, v80
  v_lshrrev_b32 v1, 4, v0
  s_lshl_b32 s30, s24, 4
  s_add_u32 s30, s30, 0
  v_add_u32 v1, s30, v1
  v_and_b32 v2, 7, v1
  v_lshlrev_b32 v2, 1, v2
  v_and_b32 v3, 15, v0
  v_xor_b32 v2, v2, v3
  v_lshlrev_b32 v2, 4, v2
  v_lshl_add_u32 v84, v1, 11, v2
  v_lshrrev_b32 v1, 4, v0
  s_lshl_b32 s30, s24, 4
  s_add_u32 s30, s30, 4
  v_add_u32 v1, s30, v1
  v_and_b32 v2, 7, v1
  v_lshlrev_b32 v2, 1, v2
  v_and_b32 v3, 15, v0
  v_xor_b32 v2, v2, v3
  v_lshlrev_b32 v2, 4, v2
  v_lshl_add_u32 v85, v1, 11, v2
  v_lshrrev_b32 v1, 4, v0
  s_lshl_b32 s30, s24, 4
  s_add_u32 s30, s30, 8
  v_add_u32 v1, s30, v1
  v_and_b32 v2, 7, v1
  v_lshlrev_b32 v2, 1, v2
  v_and_b32 v3, 15, v0
  v_xor_b32 v2, v2, v3
  v_lshlrev_b32 v2, 4, v2
  v_lshl_add_u32 v86, v1, 11, v2
  v_lshrrev_b32 v1, 4, v0
  s_lshl_b32 s30, s24, 4
  s_add_u32 s30, s30, 12
  v_add_u32 v1, s30, v1
  v_and_b32 v2, 7, v1
  v_lshlrev_b32 v2, 1, v2
  v_and_b32 v3, 15, v0
  v_xor_b32 v2, v2, v3
  v_lshlrev_b32 v2, 4, v2
  v_lshl_add_u32 v87, v1, 11, v2
  s_mov_b32 s37, 0
  s_mov_b32 s38, 0
  s_lshl_b32 s40, s24, 12
  s_add_u32 s41, s40, 65536
  s_mov_b32 s36, 0
  s_cmp_lg_u32 s24, 0
  s_cbranch_scc1 L_oproj_kernel_nopoll
  v_mov_b32 v16, s100
  v_mov_b32 v17, s101
  s_add_u32 s92, s48, 31457280
  s_addc_u32 s93, s49, 0
  s_and_b32 s93, s93, 0xffff
  s_mov_b32 s94, 393216
  s_mov_b32 s95, 0x20000
  s_lshl_b32 s30, s25, 4
  s_add_u32 s30, s30, s26
  v_and_b32 v1, 31, v0
  s_lshl_b32 s30, s30, 12
  s_add_u32 s30, s30, 262144
  v_lshl_add_u32 v24, v1, 7, s30
  s_mov_b32 exec_lo, 2147483648
  s_mov_b32 exec_hi, 0
  s_mov_b32 s34, 400000
L_poll_oproj_kernel_a:
  buffer_load_dwordx2 v[20:21], v24, s[92:95], 0 offen sc0 sc1
  s_waitcnt vmcnt(0)
  v_cmp_ne_u64 vcc, v[20:21], v[16:17]
  s_sub_u32 s34, s34, 1
  s_nop 2
  s_cmp_eq_u64 vcc, 0
  s_cbranch_scc1 L_poll_oproj_kernel_aok
  s_cmp_lg_u32 s34, 0
  s_cbranch_scc1 L_poll_oproj_kernel_a
L_poll_oproj_kernel_aok:
  s_mov_b64 exec, -1
  s_mov_b32 s34, 400000
L_poll_oproj_kernel:
  buffer_load_dwordx2 v[20:21], v24, s[92:95], 0 offen sc0 sc1
  s_waitcnt vmcnt(0)
  v_cmp_ne_u64 vcc, v[20:21], v[16:17]
  s_sub_u32 s34, s34, 1
  s_nop 2
  s_cmp_eq_u64 vcc, 0
  s_cbranch_scc1 L_poll_oproj_kernel_ok
  s_cmp_lg_u32 s34, 0
  s_cbranch_scc1 L_poll_oproj_kernel
L_poll_oproj_kernel_ok:
L_oproj_kernel_nopoll:
  s_barrier
  s_add_u32 m0, s40, 0
  s_mov_b32 s30, 0
  buffer_load_dwordx4 v80, s[8:11], s30 offen offset:0 lds
  buffer_load_dwordx4 v80, s[8:11], s30 offen offset:1024 lds
  buffer_load_dwordx4 v80, s[8:11], s30 offen offset:2048 lds
  buffer_load_dwordx4 v80, s[8:11], s30 offen offset:3072 lds
  s_add_u32 m0, s40, 16384
  s_mov_b32 s30, 4096
  buffer_load_dwordx4 v80, s[8:11], s30 offen offset:0 lds
  buffer_load_dwordx4 v80, s[8:11], s30 offen offset:1024 lds
  buffer_load_dwordx4 v80, s[8:11], s30 offen offset:2048 lds
  buffer_load_dwordx4 v80, s[8:11], s30 offen offset:3072 lds
  s_waitcnt vmcnt(4)
  s_barrier
  s_add_u32 m0, s40, 32768
  s_mov_b32 s30, 8192
  buffer_load_dwordx4 v80, s[8:11], s30 offen offset:0 lds
  buffer_load_dwordx4 v80, s[8:11], s30 offen offset:1024 lds
  buffer_load_dwordx4 v80, s[8:11], s30 offen offset:2048 lds
  buffer_load_dwordx4 v80, s[8:11], s30 offen offset:3072 lds
  s_add_u32 m0, s40, 49152
  s_mov_b32 s30, 12288
  buffer_load_dwordx4 v80, s[8:11], s30 offen offset:0 lds
  buffer_load_dwordx4 v80, s[8:11], s30 offen offset:1024 lds
  buffer_load_dwordx4 v80, s[8:11], s30 offen offset:2048 lds
  buffer_load_dwordx4 v80, s[8:11], s30 offen offset:3072 lds
  s_waitcnt vmcnt(8)
  s_barrier
  s_waitcnt vmcnt(4)
  s_barrier
  s_add_u32 m0, s40, 0
  s_mov_b32 s30, 16384
  buffer_load_dwordx4 v80, s[8:11], s30 offen offset:0 lds
  buffer_load_dwordx4 v80, s[8:11], s30 offen offset:1024 lds
  buffer_load_dwordx4 v80, s[8:11], s30 offen offset:2048 lds
  buffer_load_dwordx4 v80, s[8:11], s30 offen offset:3072 lds
  s_add_u32 m0, s41, 0
  s_mov_b32 s30, 786432
  buffer_load_dwordx4 v84, s[12:15], s30 offen lds
  s_add_u32 m0, m0, 1024
  s_nop 0
  buffer_load_dwordx4 v85, s[12:15], s30 offen lds
  s_add_u32 m0, m0, 1024
  s_nop 0
  buffer_load_dwordx4 v86, s[12:15], s30 offen lds
  s_add_u32 m0, m0, 1024
  s_nop 0
  buffer_load_dwordx4 v87, s[12:15], s30 offen lds
  s_waitcnt vmcnt(8)
  s_barrier
  s_add_u32 m0, s40, 16384
  s_mov_b32 s30, 20480
  buffer_load_dwordx4 v80, s[8:11], s30 offen offset:0 lds
  buffer_load_dwordx4 v80, s[8:11], s30 offen offset:1024 lds
  buffer_load_dwordx4 v80, s[8:11], s30 offen offset:2048 lds
  buffer_load_dwordx4 v80, s[8:11], s30 offen offset:3072 lds
  s_add_u32 m0, s41, 16384
  s_mov_b32 s30, 917504
  buffer_load_dwordx4 v84, s[12:15], s30 offen lds
  s_add_u32 m0, m0, 1024
  s_nop 0
  buffer_load_dwordx4 v85, s[12:15], s30 offen lds
  s_add_u32 m0, m0, 1024
  s_nop 0
  buffer_load_dwordx4 v86, s[12:15], s30 offen lds
  s_add_u32 m0, m0, 1024
  s_nop 0
  buffer_load_dwordx4 v87, s[12:15], s30 offen lds
  s_waitcnt vmcnt(12)
  s_barrier
  s_add_u32 m0, s40, 32768
  s_mov_b32 s30, 24576
  buffer_load_dwordx4 v80, s[8:11], s30 offen offset:0 lds
  buffer_load_dwordx4 v80, s[8:11], s30 offen offset:1024 lds
  buffer_load_dwordx4 v80, s[8:11], s30 offen offset:2048 lds
  buffer_load_dwordx4 v80, s[8:11], s30 offen offset:3072 lds
  s_add_u32 m0, s41, 32768
  s_mov_b32 s30, 1048576
  buffer_load_dwordx4 v84, s[12:15], s30 offen lds
  s_add_u32 m0, m0, 1024
  s_nop 0
  buffer_load_dwordx4 v85, s[12:15], s30 offen lds
  s_add_u32 m0, m0, 1024
  s_nop 0
  buffer_load_dwordx4 v86, s[12:15], s30 offen lds
  s_add_u32 m0, m0, 1024
  s_nop 0
  buffer_load_dwordx4 v87, s[12:15], s30 offen lds
  s_waitcnt vmcnt(12)
  s_barrier
  s_add_u32 m0, s40, 49152
  s_mov_b32 s30, 28672
  buffer_load_dwordx4 v80, s[8:11], s30 offen offset:0 lds
  buffer_load_dwordx4 v80, s[8:11], s30 offen offset:1024 lds
  buffer_load_dwordx4 v80, s[8:11], s30 offen offset:2048 lds
  buffer_load_dwordx4 v80, s[8:11], s30 offen offset:3072 lds
  s_add_u32 m0, s41, 49152
  s_mov_b32 s30, 1179648
  buffer_load_dwordx4 v84, s[12:15], s30 offen lds
  s_add_u32 m0, m0, 1024
  s_nop 0
  buffer_load_dwordx4 v85, s[12:15], s30 offen lds
  s_add_u32 m0, m0, 1024
  s_nop 0
  buffer_load_dwordx4 v86, s[12:15], s30 offen lds
  s_add_u32 m0, m0, 1024
  s_nop 0
  buffer_load_dwordx4 v87, s[12:15], s30 offen lds
  s_waitcnt vmcnt(12)
  s_barrier
  s_add_u32 m0, s40, 0
  s_mov_b32 s30, 32768
  buffer_load_dwordx4 v80, s[8:11], s30 offen offset:0 lds
  buffer_load_dwordx4 v80, s[8:11], s30 offen offset:1024 lds
  buffer_load_dwordx4 v80, s[8:11], s30 offen offset:2048 lds
  buffer_load_dwordx4 v80, s[8:11], s30 offen offset:3072 lds
  s_add_u32 m0, s41, 65536
  s_mov_b32 s30, 1310720
  buffer_load_dwordx4 v84, s[12:15], s30 offen lds
  s_add_u32 m0, m0, 1024
  s_nop 0
  buffer_load_dwordx4 v85, s[12:15], s30 offen lds
  s_add_u32 m0, m0, 1024
  s_nop 0
  buffer_load_dwordx4 v86, s[12:15], s30 offen lds
  s_add_u32 m0, m0, 1024
  s_nop 0
  buffer_load_dwordx4 v87, s[12:15], s30 offen lds
  s_waitcnt vmcnt(12)
  s_barrier
  s_add_u32 m0, s40, 16384
  s_mov_b32 s30, 36864
  buffer_load_dwordx4 v80, s[8:11], s30 offen offset:0 lds
  buffer_load_dwordx4 v80, s[8:11], s30 offen offset:1024 lds
  buffer_load_dwordx4 v80, s[8:11], s30 offen offset:2048 lds
  buffer_load_dwordx4 v80, s[8:11], s30 offen offset:3072 lds
  s_add_u32 m0, s41, 81920
  s_mov_b32 s30, 1441792
  buffer_load_dwordx4 v84, s[12:15], s30 offen lds
  s_add_u32 m0, m0, 1024
  s_nop 0
  buffer_load_dwordx4 v85, s[12:15], s30 offen lds
  s_add_u32 m0, m0, 1024
  s_nop 0
  buffer_load_dwordx4 v86, s[12:15], s30 offen lds
  s_add_u32 m0, m0, 1024
  s_nop 0
  buffer_load_dwordx4 v87, s[12:15], s30 offen lds
  s_waitcnt vmcnt(12)
  s_barrier
  s_add_u32 m0, s40, 32768
  s_mov_b32 s30, 40960
  buffer_load_dwordx4 v80, s[8:11], s30 offen offset:0 lds
  buffer_load_dwordx4 v80, s[8:11], s30 offen offset:1024 lds
  buffer_load_dwordx4 v80, s[8:11], s30 offen offset:2048 lds
  buffer_load_dwordx4 v80, s[8:11], s30 offen offset:3072 lds
  s_add_u32 m0, s41, 0
  s_mov_b32 s30, 1572864
  buffer_load_dwordx4 v84, s[12:15], s30 offen lds
  s_add_u32 m0, m0, 1024
  s_nop 0
  buffer_load_dwordx4 v85, s[12:15], s30 offen lds
  s_add_u32 m0, m0, 1024
  s_nop 0
  buffer_load_dwordx4 v86, s[12:15], s30 offen lds
  s_add_u32 m0, m0, 1024
  s_nop 0
  buffer_load_dwordx4 v87, s[12:15], s30 offen lds
  s_waitcnt vmcnt(12)
  s_barrier
  s_add_u32 m0, s40, 49152
  s_mov_b32 s30, 45056
  buffer_load_dwordx4 v80, s[8:11], s30 offen offset:0 lds
  buffer_load_dwordx4 v80, s[8:11], s30 offen offset:1024 lds
  buffer_load_dwordx4 v80, s[8:11], s30 offen offset:2048 lds
  buffer_load_dwordx4 v80, s[8:11], s30 offen offset:3072 lds
  s_add_u32 m0, s41, 16384
  s_mov_b32 s30, 1703936
  buffer_load_dwordx4 v84, s[12:15], s30 offen lds
  s_add_u32 m0, m0, 1024
  s_nop 0
  buffer_load_dwordx4 v85, s[12:15], s30 offen lds
  s_add_u32 m0, m0, 1024
  s_nop 0
  buffer_load_dwordx4 v86, s[12:15], s30 offen lds
  s_add_u32 m0, m0, 1024
  s_nop 0
  buffer_load_dwordx4 v87, s[12:15], s30 offen lds
  s_waitcnt vmcnt(12)
  s_barrier
  s_add_u32 m0, s40, 0
  s_mov_b32 s30, 49152
  buffer_load_dwordx4 v80, s[8:11], s30 offen offset:0 lds
  buffer_load_dwordx4 v80, s[8:11], s30 offen offset:1024 lds
  buffer_load_dwordx4 v80, s[8:11], s30 offen offset:2048 lds
  buffer_load_dwordx4 v80, s[8:11], s30 offen offset:3072 lds
  s_add_u32 m0, s41, 32768
  s_mov_b32 s30, 1835008
  buffer_load_dwordx4 v84, s[12:15], s30 offen lds
  s_add_u32 m0, m0, 1024
  s_nop 0
  buffer_load_dwordx4 v85, s[12:15], s30 offen lds
  s_add_u32 m0, m0, 1024
  s_nop 0
  buffer_load_dwordx4 v86, s[12:15], s30 offen lds
  s_add_u32 m0, m0, 1024
  s_nop 0
  buffer_load_dwordx4 v87, s[12:15], s30 offen lds
  s_waitcnt vmcnt(12)
  s_barrier
  s_add_u32 m0, s40, 16384
  s_mov_b32 s30, 53248
  buffer_load_dwordx4 v80, s[8:11], s30 offen offset:0 lds
  buffer_load_dwordx4 v80, s[8:11], s30 offen offset:1024 lds
  buffer_load_dwordx4 v80, s[8:11], s30 offen offset:2048 lds
  buffer_load_dwordx4 v80, s[8:11], s30 offen offset:3072 lds
  s_add_u32 m0, s41, 49152
  s_mov_b32 s30, 1966080
  buffer_load_dwordx4 v84, s[12:15], s30 offen lds
  s_add_u32 m0, m0, 1024
  s_nop 0
  buffer_load_dwordx4 v85, s[12:15], s30 offen lds
  s_add_u32 m0, m0, 1024
  s_nop 0
  buffer_load_dwordx4 v86, s[12:15], s30 offen lds
  s_add_u32 m0, m0, 1024
  s_nop 0
  buffer_load_dwordx4 v87, s[12:15], s30 offen lds
  s_waitcnt vmcnt(12)
  s_barrier
  s_add_u32 m0, s40, 32768
  s_mov_b32 s30, 57344
  buffer_load_dwordx4 v80, s[8:11], s30 offen offset:0 lds
  buffer_load_dwordx4 v80, s[8:11], s30 offen offset:1024 lds
  buffer_load_dwordx4 v80, s[8:11], s30 offen offset:2048 lds
  buffer_load_dwordx4 v80, s[8:11], s30 offen offset:3072 lds
  s_waitcnt vmcnt(8)
  s_barrier
  s_add_u32 m0, s40, 49152
  s_mov_b32 s30, 61440
  buffer_load_dwordx4 v80, s[8:11], s30 offen offset:0 lds
  buffer_load_dwordx4 v80, s[8:11], s30 offen offset:1024 lds
  buffer_load_dwordx4 v80, s[8:11], s30 offen offset:2048 lds
  buffer_load_dwordx4 v80, s[8:11], s30 offen offset:3072 lds
  s_waitcnt vmcnt(4)
  s_barrier
  s_waitcnt vmcnt(0)
  s_barrier
  s_branch L_oproj_kernel_end
L_oproj_kernel_compute:
  s_lshr_b32 s30, s24, 1
  s_and_b32 s31, s24, 1
  v_and_b32 v1, 15, v0
  v_lshrrev_b32 v2, 4, v0
  v_lshlrev_b32 v6, 9, v2
  v_lshl_add_u32 v6, v1, 4, v6
  s_lshl_b32 s32, s30, 13
  v_add_u32 v6, s32, v6
  v_lshrrev_b32 v3, 2, v1
  v_and_b32 v4, 1, v2
  v_lshl_or_b32 v3, v4, 2, v3
  v_lshrrev_b32 v4, 1, v2
  v_lshl_add_u32 v5, v4, 4, v3
  v_lshlrev_b32 v5, 8, v5
  v_lshlrev_b32 v3, 1, v3
  v_and_b32 v4, 1, v1
  v_lshl_add_u32 v5, v4, 3, v5
  v_add_u32 v5, 65536, v5
  v_bfe_u32 v4, v1, 1, 1
  s_lshl_b32 s32, s31, 3
  v_add_u32 v4, s32, v4
  v_add_u32 v7, 0, v4
  v_xor_b32 v7, v7, v3
  v_lshl_add_u32 v7, v7, 4, v5
  v_add_u32 v8, 2, v4
  v_xor_b32 v8, v8, v3
  v_lshl_add_u32 v8, v8, 4, v5
  v_add_u32 v9, 4, v4
  v_xor_b32 v9, v9, v3
  v_lshl_add_u32 v9, v9, 4, v5
  v_add_u32 v10, 6, v4
  v_xor_b32 v10, v10, v3
  v_lshl_add_u32 v10, v10, 4, v5
  v_and_b32 v3, 1, v2
  v_lshlrev_b32 v3, 5, v3
  v_lshrrev_b32 v4, 1, v2
  v_lshl_add_u32 v3, v4, 4, v3
  v_lshrrev_b32 v4, 3, v1
  v_lshl_add_u32 v3, v4, 6, v3
  v_and_b32 v4, 7, v1
  v_lshl_add_u32 v11, v4, 12, v3
  s_lshl_b32 s43, s26, 19
  s_lshl_b32 s32, s30, 18
  s_add_u32 s43, s43, s32
  s_lshl_b32 s32, s25, 11
  s_add_u32 s43, s43, s32
  s_lshl_b32 s32, s27, 8
  s_add_u32 s43, s43, s32
  s_lshl_b32 s32, s31, 7
  s_add_u32 s43, s43, s32
  s_mov_b32 s45, 4294868992
  s_mov_b32 s36, 0
  s_mov_b32 s46, 0
  s_mov_b32 s57, 4294918144
  s_mov_b32 s58, 4294885376
  v_mov_b32 v16, 0
  v_mov_b32 v17, 0
  v_mov_b32 v18, 0
  v_mov_b32 v19, 0
  v_mov_b32 v20, 0
  v_mov_b32 v21, 0
  v_mov_b32 v22, 0
  v_mov_b32 v23, 0
  v_mov_b32 v24, 0
  v_mov_b32 v25, 0
  v_mov_b32 v26, 0
  v_mov_b32 v27, 0
  v_mov_b32 v28, 0
  v_mov_b32 v29, 0
  v_mov_b32 v30, 0
  v_mov_b32 v31, 0
  v_mov_b32 v32, 0
  v_mov_b32 v33, 0
  v_mov_b32 v34, 0
  v_mov_b32 v35, 0
  v_mov_b32 v36, 0
  v_mov_b32 v37, 0
  v_mov_b32 v38, 0
  v_mov_b32 v39, 0
  v_mov_b32 v40, 0
  v_mov_b32 v41, 0
  v_mov_b32 v42, 0
  v_mov_b32 v43, 0
  v_mov_b32 v44, 0
  v_mov_b32 v45, 0
  v_mov_b32 v46, 0
  v_mov_b32 v47, 0
  v_mov_b32 v48, 0
  v_mov_b32 v49, 0
  v_mov_b32 v50, 0
  v_mov_b32 v51, 0
  v_mov_b32 v52, 0
  v_mov_b32 v53, 0
  v_mov_b32 v54, 0
  v_mov_b32 v55, 0
  v_mov_b32 v56, 0
  v_mov_b32 v57, 0
  v_mov_b32 v58, 0
  v_mov_b32 v59, 0
  v_mov_b32 v60, 0
  v_mov_b32 v61, 0
  v_mov_b32 v62, 0
  v_mov_b32 v63, 0
  v_mov_b32 v64, 0
  v_mov_b32 v65, 0
  v_mov_b32 v66, 0
  v_mov_b32 v67, 0
  v_mov_b32 v68, 0
  v_mov_b32 v69, 0
  v_mov_b32 v70, 0
  v_mov_b32 v71, 0
  v_mov_b32 v72, 0
  v_mov_b32 v73, 0
  v_mov_b32 v74, 0
  v_mov_b32 v75, 0
  v_mov_b32 v76, 0
  v_mov_b32 v77, 0
  v_mov_b32 v78, 0
  v_mov_b32 v79, 0
  s_barrier
  s_barrier
  ds_read_b64_tr_b16 v[112:113], v7 offset:0
  ds_read_b64_tr_b16 v[114:115], v7 offset:2048
  ds_read_b128 v[80:83], v6 offset:0
  ds_read_b64_tr_b16 v[116:117], v8 offset:0
  ds_read_b64_tr_b16 v[118:119], v8 offset:2048
  ds_read_b64_tr_b16 v[120:121], v9 offset:0
  ds_read_b64_tr_b16 v[122:123], v9 offset:2048
  ds_read_b64_tr_b16 v[124:125], v10 offset:0
  ds_read_b64_tr_b16 v[126:127], v10 offset:2048
  ds_read_b128 v[84:87], v6 offset:256
  ds_read_b128 v[88:91], v6 offset:4096
  ds_read_b128 v[92:95], v6 offset:4352
  s_mov_b32 s34, 15
  .p2align 6
L_oproj_kernel_loop:
  s_waitcnt lgkmcnt(3)
  v_mfma_f32_16x16x32_bf16 v[16:19], v[112:115], v[80:83], v[16:19]
  ds_read_b64_tr_b16 v[128:129], v7 offset:8192
  s_add_u32 s36, s36, 1
  v_mfma_f32_16x16x32_bf16 v[20:23], v[116:119], v[80:83], v[20:23]
  ds_read_b64_tr_b16 v[130:131], v7 offset:10240
  s_cmp_eq_u32 s36, 4
  v_mfma_f32_16x16x32_bf16 v[24:27], v[120:123], v[80:83], v[24:27]
  ds_read_b128 v[96:99], v6 offset:2048
  s_cselect_b32 s35, s57, 16384
  v_mfma_f32_16x16x32_bf16 v[28:31], v[124:127], v[80:83], v[28:31]
  ds_read_b64_tr_b16 v[132:133], v8 offset:8192
  s_waitcnt lgkmcnt(6)
  v_mfma_f32_16x16x32_bf16 v[32:35], v[112:115], v[84:87], v[32:35]
  ds_read_b64_tr_b16 v[134:135], v8 offset:10240
  s_cselect_b32 s36, 0, s36
  v_mfma_f32_16x16x32_bf16 v[36:39], v[116:119], v[84:87], v[36:39]
  ds_read_b64_tr_b16 v[136:137], v9 offset:8192
  s_add_u32 s46, s46, 1
  v_mfma_f32_16x16x32_bf16 v[40:43], v[120:123], v[84:87], v[40:43]
  ds_read_b64_tr_b16 v[138:139], v9 offset:10240
  s_cmp_eq_u32 s46, 6
  v_mfma_f32_16x16x32_bf16 v[44:47], v[124:127], v[84:87], v[44:47]
  ds_read_b64_tr_b16 v[140:141], v10 offset:8192
  s_waitcnt lgkmcnt(9)
  v_mfma_f32_16x16x32_bf16 v[48:51], v[112:115], v[88:91], v[48:51]
  ds_read_b64_tr_b16 v[142:143], v10 offset:10240
  s_cselect_b32 s47, s58, 16384
  v_mfma_f32_16x16x32_bf16 v[52:55], v[116:119], v[88:91], v[52:55]
  ds_read_b128 v[100:103], v6 offset:2304
  s_cselect_b32 s46, 0, s46
  v_mfma_f32_16x16x32_bf16 v[56:59], v[120:123], v[88:91], v[56:59]
  ds_read_b128 v[104:107], v6 offset:6144
  v_mfma_f32_16x16x32_bf16 v[60:63], v[124:127], v[88:91], v[60:63]
  ds_read_b128 v[108:111], v6 offset:6400
  s_waitcnt lgkmcnt(12)
  v_mfma_f32_16x16x32_bf16 v[64:67], v[112:115], v[92:95], v[64:67]
  v_add_u32 v6, s35, v6
  v_add_u32 v7, s47, v7
  v_mfma_f32_16x16x32_bf16 v[68:71], v[116:119], v[92:95], v[68:71]
  v_add_u32 v8, s47, v8
  v_add_u32 v9, s47, v9
  v_mfma_f32_16x16x32_bf16 v[72:75], v[120:123], v[92:95], v[72:75]
  v_add_u32 v10, s47, v10
  v_mfma_f32_16x16x32_bf16 v[76:79], v[124:127], v[92:95], v[76:79]
  s_barrier
  s_waitcnt lgkmcnt(3)
  v_mfma_f32_16x16x32_bf16 v[16:19], v[128:131], v[96:99], v[16:19]
  ds_read_b64_tr_b16 v[112:113], v7 offset:0
  s_sub_u32 s34, s34, 1
  v_mfma_f32_16x16x32_bf16 v[20:23], v[132:135], v[96:99], v[20:23]
  ds_read_b64_tr_b16 v[114:115], v7 offset:2048
  s_cmp_lg_u32 s34, 0
  v_mfma_f32_16x16x32_bf16 v[24:27], v[136:139], v[96:99], v[24:27]
  ds_read_b128 v[80:83], v6 offset:0
  v_mfma_f32_16x16x32_bf16 v[28:31], v[140:143], v[96:99], v[28:31]
  ds_read_b64_tr_b16 v[116:117], v8 offset:0
  s_waitcnt lgkmcnt(6)
  v_mfma_f32_16x16x32_bf16 v[32:35], v[128:131], v[100:103], v[32:35]
  ds_read_b64_tr_b16 v[118:119], v8 offset:2048
  v_mfma_f32_16x16x32_bf16 v[36:39], v[132:135], v[100:103], v[36:39]
  ds_read_b64_tr_b16 v[120:121], v9 offset:0
  v_mfma_f32_16x16x32_bf16 v[40:43], v[136:139], v[100:103], v[40:43]
  ds_read_b64_tr_b16 v[122:123], v9 offset:2048
  v_mfma_f32_16x16x32_bf16 v[44:47], v[140:143], v[100:103], v[44:47]
  ds_read_b64_tr_b16 v[124:125], v10 offset:0
  s_waitcnt lgkmcnt(9)
  v_mfma_f32_16x16x32_bf16 v[48:51], v[128:131], v[104:107], v[48:51]
  ds_read_b64_tr_b16 v[126:127], v10 offset:2048
  v_mfma_f32_16x16x32_bf16 v[52:55], v[132:135], v[104:107], v[52:55]
  ds_read_b128 v[84:87], v6 offset:256
  v_mfma_f32_16x16x32_bf16 v[56:59], v[136:139], v[104:107], v[56:59]
  ds_read_b128 v[88:91], v6 offset:4096
  v_mfma_f32_16x16x32_bf16 v[60:63], v[140:143], v[104:107], v[60:63]
  ds_read_b128 v[92:95], v6 offset:4352
  s_waitcnt lgkmcnt(12)
  v_mfma_f32_16x16x32_bf16 v[64:67], v[128:131], v[108:111], v[64:67]
  v_mfma_f32_16x16x32_bf16 v[68:71], v[132:135], v[108:111], v[68:71]
  v_mfma_f32_16x16x32_bf16 v[72:75], v[136:139], v[108:111], v[72:75]
  v_mfma_f32_16x16x32_bf16 v[76:79], v[140:143], v[108:111], v[76:79]
  s_cbranch_scc1 L_oproj_kernel_loop
  s_waitcnt lgkmcnt(9)
  v_mfma_f32_16x16x32_bf16 v[16:19], v[112:115], v[80:83], v[16:19]
  ds_read_b64_tr_b16 v[128:129], v7 offset:8192
  ds_read_b64_tr_b16 v[130:131], v7 offset:10240
  s_waitcnt lgkmcnt(9)
  v_mfma_f32_16x16x32_bf16 v[20:23], v[116:119], v[80:83], v[20:23]
  ds_read_b128 v[96:99], v6 offset:2048
  s_waitcnt lgkmcnt(8)
  v_mfma_f32_16x16x32_bf16 v[24:27], v[120:123], v[80:83], v[24:27]
  ds_read_b64_tr_b16 v[132:133], v8 offset:8192
  ds_read_b64_tr_b16 v[134:135], v8 offset:10240
  s_waitcnt lgkmcnt(8)
  v_mfma_f32_16x16x32_bf16 v[28:31], v[124:127], v[80:83], v[28:31]
  ds_read_b64_tr_b16 v[136:137], v9 offset:8192
  s_waitcnt lgkmcnt(8)
  v_mfma_f32_16x16x32_bf16 v[32:35], v[112:115], v[84:87], v[32:35]
  ds_read_b64_tr_b16 v[138:139], v9 offset:10240
  ds_read_b64_tr_b16 v[140:141], v10 offset:8192
  v_mfma_f32_16x16x32_bf16 v[36:39], v[116:119], v[84:87], v[36:39]
  ds_read_b64_tr_b16 v[142:143], v10 offset:10240
  v_mfma_f32_16x16x32_bf16 v[40:43], v[120:123], v[84:87], v[40:43]
  ds_read_b128 v[100:103], v6 offset:2304
  ds_read_b128 v[104:107], v6 offset:6144
  v_mfma_f32_16x16x32_bf16 v[44:47], v[124:127], v[84:87], v[44:47]
  ds_read_b128 v[108:111], v6 offset:6400
  s_waitcnt lgkmcnt(9)
  v_mfma_f32_16x16x32_bf16 v[16:19], v[128:131], v[96:99], v[16:19]
  s_waitcnt lgkmcnt(7)
  v_mfma_f32_16x16x32_bf16 v[20:23], v[132:135], v[96:99], v[20:23]
  s_waitcnt lgkmcnt(5)
  v_mfma_f32_16x16x32_bf16 v[24:27], v[136:139], v[96:99], v[24:27]
  s_waitcnt lgkmcnt(3)
  v_mfma_f32_16x16x32_bf16 v[28:31], v[140:143], v[96:99], v[28:31]
  s_waitcnt lgkmcnt(2)
  v_mfma_f32_16x16x32_bf16 v[32:35], v[128:131], v[100:103], v[32:35]
  v_mfma_f32_16x16x32_bf16 v[36:39], v[132:135], v[100:103], v[36:39]
  v_mfma_f32_16x16x32_bf16 v[40:43], v[136:139], v[100:103], v[40:43]
  v_mfma_f32_16x16x32_bf16 v[44:47], v[140:143], v[100:103], v[44:47]
  v_mfma_f32_16x16x32_bf16 v[48:51], v[112:115], v[88:91], v[48:51]
  v_cvt_pk_bf16_f32 v80, v16, v17
  v_cvt_pk_bf16_f32 v81, v18, v19
  v_cvt_pk_bf16_f32 v82, v20, v21
  v_cvt_pk_bf16_f32 v83, v22, v23
  v_mfma_f32_16x16x32_bf16 v[52:55], v[116:119], v[88:91], v[52:55]
  s_nop 1
  v_permlane16_swap_b32 v80, v82
  v_permlane16_swap_b32 v81, v83
  v_cvt_pk_bf16_f32 v84, v24, v25
  v_mfma_f32_16x16x32_bf16 v[56:59], v[120:123], v[88:91], v[56:59]
  v_cvt_pk_bf16_f32 v85, v26, v27
  v_cvt_pk_bf16_f32 v86, v28, v29
  v_cvt_pk_bf16_f32 v87, v30, v31
  s_nop 1
  v_mfma_f32_16x16x32_bf16 v[60:63], v[124:127], v[88:91], v[60:63]
  v_permlane16_swap_b32 v84, v86
  v_permlane16_swap_b32 v85, v87
  v_mov_b32_dpp v96, v80 row_ror:8 row_mask:0xf bank_mask:0xf
  v_mfma_f32_16x16x32_bf16 v[64:67], v[112:115], v[92:95], v[64:67]
  v_mov_b32_dpp v97, v81 row_ror:8 row_mask:0xf bank_mask:0xf
  v_mov_b32_dpp v98, v82 row_ror:8 row_mask:0xf bank_mask:0xf
  v_mov_b32_dpp v99, v83 row_ror:8 row_mask:0xf bank_mask:0xf
  v_mov_b32_dpp v80, v84 row_ror:8 row_mask:0xf bank_mask:0xc
  v_mfma_f32_16x16x32_bf16 v[68:71], v[116:119], v[92:95], v[68:71]
  v_mov_b32_dpp v81, v85 row_ror:8 row_mask:0xf bank_mask:0xc
  v_mov_b32_dpp v82, v86 row_ror:8 row_mask:0xf bank_mask:0xc
  v_mov_b32_dpp v83, v87 row_ror:8 row_mask:0xf bank_mask:0xc
  v_mov_b32_dpp v84, v96 quad_perm:[0,1,2,3] row_mask:0xf bank_mask:0x3
  v_mfma_f32_16x16x32_bf16 v[72:75], v[120:123], v[92:95], v[72:75]
  v_mov_b32_dpp v85, v97 quad_perm:[0,1,2,3] row_mask:0xf bank_mask:0x3
  v_mov_b32_dpp v86, v98 quad_perm:[0,1,2,3] row_mask:0xf bank_mask:0x3
  v_mov_b32_dpp v87, v99 quad_perm:[0,1,2,3] row_mask:0xf bank_mask:0x3
  s_add_u32 s30, s43, 0
  v_mfma_f32_16x16x32_bf16 v[76:79], v[124:127], v[92:95], v[76:79]
  buffer_store_dwordx4 v[80:83], v11, s[16:19], s30 offen sc0 sc1
  s_add_u32 s30, s43, 32768
  buffer_store_dwordx4 v[84:87], v11, s[16:19], s30 offen sc0 sc1
  s_waitcnt lgkmcnt(1)
  v_mfma_f32_16x16x32_bf16 v[48:51], v[128:131], v[104:107], v[48:51]
  v_cvt_pk_bf16_f32 v88, v32, v33
  v_cvt_pk_bf16_f32 v89, v34, v35
  v_cvt_pk_bf16_f32 v90, v36, v37
  v_cvt_pk_bf16_f32 v91, v38, v39
  v_mfma_f32_16x16x32_bf16 v[52:55], v[132:135], v[104:107], v[52:55]
  s_nop 1
  v_permlane16_swap_b32 v88, v90
  v_permlane16_swap_b32 v89, v91
  v_cvt_pk_bf16_f32 v92, v40, v41
  v_mfma_f32_16x16x32_bf16 v[56:59], v[136:139], v[104:107], v[56:59]
  v_cvt_pk_bf16_f32 v93, v42, v43
  v_cvt_pk_bf16_f32 v94, v44, v45
  v_cvt_pk_bf16_f32 v95, v46, v47
  s_nop 1
  v_mfma_f32_16x16x32_bf16 v[60:63], v[140:143], v[104:107], v[60:63]
  v_permlane16_swap_b32 v92, v94
  v_permlane16_swap_b32 v93, v95
  v_mov_b32_dpp v100, v88 row_ror:8 row_mask:0xf bank_mask:0xf
  s_waitcnt lgkmcnt(0)
  v_mfma_f32_16x16x32_bf16 v[64:67], v[128:131], v[108:111], v[64:67]
  v_mov_b32_dpp v101, v89 row_ror:8 row_mask:0xf bank_mask:0xf
  v_mov_b32_dpp v102, v90 row_ror:8 row_mask:0xf bank_mask:0xf
  v_mov_b32_dpp v103, v91 row_ror:8 row_mask:0xf bank_mask:0xf
  v_mov_b32_dpp v88, v92 row_ror:8 row_mask:0xf bank_mask:0xc
  v_mfma_f32_16x16x32_bf16 v[68:71], v[132:135], v[108:111], v[68:71]
  v_mov_b32_dpp v89, v93 row_ror:8 row_mask:0xf bank_mask:0xc
  v_mov_b32_dpp v90, v94 row_ror:8 row_mask:0xf bank_mask:0xc
  v_mov_b32_dpp v91, v95 row_ror:8 row_mask:0xf bank_mask:0xc
  v_mov_b32_dpp v92, v100 quad_perm:[0,1,2,3] row_mask:0xf bank_mask:0x3
  v_mfma_f32_16x16x32_bf16 v[72:75], v[136:139], v[108:111], v[72:75]
  v_mov_b32_dpp v93, v101 quad_perm:[0,1,2,3] row_mask:0xf bank_mask:0x3
  v_mov_b32_dpp v94, v102 quad_perm:[0,1,2,3] row_mask:0xf bank_mask:0x3
  v_mov_b32_dpp v95, v103 quad_perm:[0,1,2,3] row_mask:0xf bank_mask:0x3
  s_add_u32 s30, s43, 65536
  v_mfma_f32_16x16x32_bf16 v[76:79], v[140:143], v[108:111], v[76:79]
  buffer_store_dwordx4 v[88:91], v11, s[16:19], s30 offen sc0 sc1
  s_add_u32 s30, s43, 98304
  buffer_store_dwordx4 v[92:95], v11, s[16:19], s30 offen sc0 sc1
  s_nop 7
  v_cvt_pk_bf16_f32 v80, v48, v49
  v_cvt_pk_bf16_f32 v81, v50, v51
  v_cvt_pk_bf16_f32 v82, v52, v53
  v_cvt_pk_bf16_f32 v83, v54, v55
  s_nop 1
  v_permlane16_swap_b32 v80, v82
  v_permlane16_swap_b32 v81, v83
  v_cvt_pk_bf16_f32 v84, v56, v57
  v_cvt_pk_bf16_f32 v85, v58, v59
  v_cvt_pk_bf16_f32 v86, v60, v61
  v_cvt_pk_bf16_f32 v87, v62, v63
  s_nop 1
  v_permlane16_swap_b32 v84, v86
  v_permlane16_swap_b32 v85, v87
  v_mov_b32_dpp v96, v80 row_ror:8 row_mask:0xf bank_mask:0xf
  v_mov_b32_dpp v97, v81 row_ror:8 row_mask:0xf bank_mask:0xf
  v_mov_b32_dpp v98, v82 row_ror:8 row_mask:0xf bank_mask:0xf
  v_mov_b32_dpp v99, v83 row_ror:8 row_mask:0xf bank_mask:0xf
  v_mov_b32_dpp v80, v84 row_ror:8 row_mask:0xf bank_mask:0xc
  v_mov_b32_dpp v81, v85 row_ror:8 row_mask:0xf bank_mask:0xc
  v_mov_b32_dpp v82, v86 row_ror:8 row_mask:0xf bank_mask:0xc
  v_mov_b32_dpp v83, v87 row_ror:8 row_mask:0xf bank_mask:0xc
  v_mov_b32_dpp v84, v96 quad_perm:[0,1,2,3] row_mask:0xf bank_mask:0x3
  v_mov_b32_dpp v85, v97 quad_perm:[0,1,2,3] row_mask:0xf bank_mask:0x3
  v_mov_b32_dpp v86, v98 quad_perm:[0,1,2,3] row_mask:0xf bank_mask:0x3
  v_mov_b32_dpp v87, v99 quad_perm:[0,1,2,3] row_mask:0xf bank_mask:0x3
  s_add_u32 s30, s43, 131072
  buffer_store_dwordx4 v[80:83], v11, s[16:19], s30 offen sc0 sc1
  s_add_u32 s30, s43, 163840
  buffer_store_dwordx4 v[84:87], v11, s[16:19], s30 offen sc0 sc1
  v_cvt_pk_bf16_f32 v88, v64, v65
  v_cvt_pk_bf16_f32 v89, v66, v67
  v_cvt_pk_bf16_f32 v90, v68, v69
  v_cvt_pk_bf16_f32 v91, v70, v71
  s_nop 1
  v_permlane16_swap_b32 v88, v90
  v_permlane16_swap_b32 v89, v91
  v_cvt_pk_bf16_f32 v92, v72, v73
  v_cvt_pk_bf16_f32 v93, v74, v75
  v_cvt_pk_bf16_f32 v94, v76, v77
  v_cvt_pk_bf16_f32 v95, v78, v79
  s_nop 1
  v_permlane16_swap_b32 v92, v94
  v_permlane16_swap_b32 v93, v95
  v_mov_b32_dpp v100, v88 row_ror:8 row_mask:0xf bank_mask:0xf
  v_mov_b32_dpp v101, v89 row_ror:8 row_mask:0xf bank_mask:0xf
  v_mov_b32_dpp v102, v90 row_ror:8 row_mask:0xf bank_mask:0xf
  v_mov_b32_dpp v103, v91 row_ror:8 row_mask:0xf bank_mask:0xf
  v_mov_b32_dpp v88, v92 row_ror:8 row_mask:0xf bank_mask:0xc
  v_mov_b32_dpp v89, v93 row_ror:8 row_mask:0xf bank_mask:0xc
  v_mov_b32_dpp v90, v94 row_ror:8 row_mask:0xf bank_mask:0xc
  v_mov_b32_dpp v91, v95 row_ror:8 row_mask:0xf bank_mask:0xc
  v_mov_b32_dpp v92, v100 quad_perm:[0,1,2,3] row_mask:0xf bank_mask:0x3
  v_mov_b32_dpp v93, v101 quad_perm:[0,1,2,3] row_mask:0xf bank_mask:0x3
  v_mov_b32_dpp v94, v102 quad_perm:[0,1,2,3] row_mask:0xf bank_mask:0x3
  v_mov_b32_dpp v95, v103 quad_perm:[0,1,2,3] row_mask:0xf bank_mask:0x3
  s_add_u32 s30, s43, 196608
  buffer_store_dwordx4 v[88:91], v11, s[16:19], s30 offen sc0 sc1
  s_add_u32 s30, s43, 229376
  buffer_store_dwordx4 v[92:95], v11, s[16:19], s30 offen sc0 sc1
  s_branch L_oproj_kernel_done
L_oproj_kernel_done:
L_oproj_kernel_end:
L_fused_end:
  s_endpgm
.section .rodata,"a"
.p2align 6
.amdhsa_kernel fused_kernel
  .amdhsa_next_free_vgpr 252
  .amdhsa_next_free_sgpr 102
  .amdhsa_accum_offset 252
  .amdhsa_group_segment_fixed_size 0
  .amdhsa_kernarg_size 88
  .amdhsa_user_sgpr_count 2
  .amdhsa_user_sgpr_kernarg_segment_ptr 1
  .amdhsa_system_sgpr_workgroup_id_x 1
  .amdhsa_float_denorm_mode_32 3
.end_amdhsa_kernel
.text
L_code_end:
  s_endpgm
```
